```python
import torch

def _softmax(x, axis=-1):
    return torch.softmax(x, dim=axis)
def _gelu(x):
    return torch.nn.functional.gelu(x, approximate="tanh")
def _silu(x):
    return torch.nn.functional.silu(x)
def _sigmoid(x):
    return torch.sigmoid(x)
def _layernorm(x, axis=-1, eps=1e-5):
    m = x.mean(dim=axis, keepdim=True)
    v = x.var(dim=axis, keepdim=True, unbiased=False)
    return (x - m) / torch.sqrt(v + eps)
def _scatter_add(tgt, idx, src, axis=0):
    return tgt.clone().index_add_(axis, idx, src)
def _segment_sum(src, seg, n):
    out = torch.zeros((n,) + src.shape[1:], dtype=src.dtype)
    return out.index_add_(0, seg, src)
def _pad(x, pw):
    flat = tuple(v for pair in reversed(pw) for v in pair)
    return torch.nn.functional.pad(x, flat)

kernel_name = 'parallel_sum__softmax_full_mha__swiglu_ffn__prompt'

def setup_inputs():

    _w = (lambda a: (lambda t: t.to(torch.bfloat16) if t.is_floating_point() else t)(torch.as_tensor(a)))
    def _A_setup():
        B, S, D = 1, 2048, 448
        return {
            "x": _w((lambda *s: torch.randn(*s, dtype=torch.bfloat16) * 0.05)(B, S, D)),
            "wqkv": _w((lambda *s: torch.randn(*s, dtype=torch.bfloat16) * 0.2)(D, 3 * D)),
            "wo": _w((lambda *s: torch.randn(*s, dtype=torch.bfloat16) * 0.1)(D, D)),
        }
    _A_in = _A_setup()

    def _B_setup():
        B, S, D, F = 1, 2048, 448, 1792
        return {
            "x": _w((lambda *s: torch.randn(*s, dtype=torch.bfloat16) * 0.05)(B, S, D)),
            "w_gate": _w((lambda *s: torch.randn(*s, dtype=torch.bfloat16) * 0.1)(D, F)),
            "w_up": _w((lambda *s: torch.randn(*s, dtype=torch.bfloat16) * 0.1)(D, F)),
            "w_down": _w((lambda *s: torch.randn(*s, dtype=torch.bfloat16) * 0.1)(F, D)),
        }
    _B_in = _B_setup()

    return {
        "A_x": _A_in["x"],
        "A_wqkv": _A_in["wqkv"],
        "A_wo": _A_in["wo"],
        "B_x": _B_in["x"],
        "B_w_gate": _B_in["w_gate"],
        "B_w_up": _B_in["w_up"],
        "B_w_down": _B_in["w_down"],
    }

def reference(A_x, A_wqkv, A_wo, B_x, B_w_gate, B_w_up, B_w_down):
    def _A_ref(x, wqkv, wo):
        B, S, D = x.shape
        H = 16; Dh = D // H
        qkv = (lambda x, *d: x.permute(*d))((x @ wqkv).reshape(B, S, 3, H, Dh), 2, 0, 3, 1, 4)
        q, k, v = qkv[0], qkv[1], qkv[2]
        scale = Dh ** -0.5
        scores = torch.einsum("bhqd,bhkd->bhqk", q, k) * scale
        p = _softmax(scores, axis=-1)
        o = torch.einsum("bhqk,bhkd->bhqd", p, v)
        return (lambda x, *d: x.permute(*d))(o, 0, 2, 1, 3).reshape(B, S, D) @ wo

    def _B_ref(x, w_gate, w_up, w_down):
        g = _silu(x @ w_gate)
        u = x @ w_up
        return (g * u) @ w_down

    x = A_x
    xn = _layernorm(x, axis=-1)
    return x + _A_ref(xn, A_wqkv, A_wo) + _B_ref(xn, B_w_gate, B_w_up, B_w_down)
```

```asm
; @launch grid=(256,1,1) block=(512,1,1) lds=163840
.amdgcn_target "amdgcn-amd-amdhsa--gfx950"
.text
.globl parallel_sum__softmax_full_mha__swiglu_ffn__prompt_kernel
.p2align 8
.type parallel_sum__softmax_full_mha__swiglu_ffn__prompt_kernel,@function
parallel_sum__softmax_full_mha__swiglu_ffn__prompt_kernel:
    s_cmp_ge_u32 s2, 256
    s_cbranch_scc1 parallel_sum__softmax_full_mha__swiglu_ffn__prompt_kernel_end
    s_load_dwordx2 s[96:97], s[0:1], 0
    s_load_dwordx2 s[6:7], s[0:1], 8
    s_load_dwordx4 s[24:27], s[0:1], 32
    s_load_dwordx2 s[4:5], s[0:1], 72
    s_load_dwordx2 s[100:101], s[0:1], 64
    s_load_dwordx2 s[28:29], s[0:1], 48
    s_load_dwordx2 s[38:39], s[0:1], 56
    s_getpc_b64 s[74:75]
parallel_sum__softmax_full_mha__swiglu_ffn__prompt_kernel_a_pcbase:
    v_and_b32 v20, 63, v0
    v_lshrrev_b32 v19, 6, v0
    s_nop 0
    v_readfirstlane_b32 s30, v19
    s_nop 0
    s_cmp_eq_u32 s30, 7
    s_cbranch_scc0 parallel_sum__softmax_full_mha__swiglu_ffn__prompt_kernel_a_nocp
    s_lshr_b32 s58, s2, 3
    s_lshl_b32 s58, s58, 11
    v_lshlrev_b32 v18, 7, v20
    v_add_u32 v18, s58, v18
    v_min_u32 v18, parallel_sum__softmax_full_mha__swiglu_ffn__prompt_kernel_end-parallel_sum__softmax_full_mha__swiglu_ffn__prompt_kernel_a_pcbase-4, v18
    s_mov_b32 exec_lo, 0xffff
    s_mov_b32 exec_hi, 0
    global_load_dword v255, v18, s[74:75]
    s_mov_b64 exec, -1
parallel_sum__softmax_full_mha__swiglu_ffn__prompt_kernel_a_nocp:
    v_lshlrev_b32 v1, 4, v20
    v_and_b32 v21, 31, v0
    v_bfe_u32 v22, v0, 5, 1
    s_and_b32 s58, s2, 1
    s_lshl_b32 s58, s58, 3
    s_lshr_b32 s59, s2, 3
    s_and_b32 s60, s59, 7
    s_add_u32 s33, s58, s60
    s_and_b32 s58, s2, 7
    s_lshr_b32 s58, s58, 1
    s_lshl_b32 s58, s58, 2
    s_lshr_b32 s59, s59, 3
    s_add_u32 s34, s58, s59
    s_lshl_b32 s58, s33, 7
    s_lshl_b32 s59, s30, 4
    s_add_u32 s58, s58, s59
    s_mul_i32 s68, s58, 896
    s_add_u32 s69, s68, 7168
    s_lshl_b32 s70, s30, 11
    v_lshrrev_b32 v18, 3, v20
    v_mul_u32_u24 v18, 896, v18
    v_and_b32 v23, 7, v20
    v_lshlrev_b32 v19, 4, v23
    v_add_u32 v250, v18, v19
    s_mov_b32 s98, 1835008
    s_mov_b32 s99, 0x20000
    s_waitcnt lgkmcnt(0)
    s_add_u32 s58, s2, s30
    s_cmp_eq_u32 s58, 0
    s_cbranch_scc0 parallel_sum__softmax_full_mha__swiglu_ffn__prompt_kernel_a_notag
    s_memrealtime s[60:61]
    s_waitcnt lgkmcnt(0)
    s_waitcnt lgkmcnt(0)
    s_or_b32 s60, s60, 1
    v_mov_b32 v18, s60
    v_mov_b32 v19, 0
    global_store_dword v19, v18, s[100:101] sc1
parallel_sum__softmax_full_mha__swiglu_ffn__prompt_kernel_a_notag:
    s_mov_b32 s60, 7
parallel_sum__softmax_full_mha__swiglu_ffn__prompt_kernel_a_xloop:
    s_mov_b32 m0, s70
    s_addk_i32 s70, 16384
    buffer_load_dwordx4 v250, s[96:99], s68 offen lds
    s_addk_i32 m0, 1024
    s_addk_i32 s68, 128
    buffer_load_dwordx4 v250, s[96:99], s69 offen lds
    s_addk_i32 s69, 128
    s_sub_u32 s60, s60, 1
    s_cmp_lg_u32 s60, 0
    s_cbranch_scc1 parallel_sum__softmax_full_mha__swiglu_ffn__prompt_kernel_a_xloop
    v_mov_b32 v27, 0
    global_load_dword v26, v27, s[100:101] sc1
    s_mov_b32 s8, s6
    s_mov_b32 s9, s7
    s_mov_b32 s10, 1204224
    s_mov_b32 s11, 0x20000
    s_mov_b32 s12, s24
    s_mov_b32 s13, s25
    s_mov_b32 s14, 1605632
    s_mov_b32 s15, 0x20000
    s_mov_b32 s16, s26
    s_mov_b32 s17, s27
    s_mov_b32 s18, 1605632
    s_mov_b32 s19, 0x20000
    s_mov_b32 s20, s4
    s_mov_b32 s21, s5
    s_mov_b32 s22, 20971520
    s_mov_b32 s23, 0x20000
    s_load_dwordx2 s[4:5], s[0:1], 16
    s_waitcnt lgkmcnt(0)
    v_lshlrev_b32 v18, 7, v20
    s_cmp_eq_u32 s30, 4
    s_cbranch_scc0 parallel_sum__softmax_full_mha__swiglu_ffn__prompt_kernel_a_wu0
    s_mul_i32 s58, s2, 4736
    s_mov_b32 exec_hi, 0x000000ff
    buffer_load_dword v252, v18, s[8:11], s58 offen
    s_mov_b64 exec, -1
parallel_sum__softmax_full_mha__swiglu_ffn__prompt_kernel_a_wu0:
    s_and_b32 s31, s30, 3
    s_lshr_b32 s32, s30, 2
    s_lshr_b32 s35, s34, 1
    s_and_b32 s37, s34, 1
    s_mul_i32 s58, s35, 7
    s_and_b32 s59, s35, 1
    s_add_u32 s60, s58, s59
    s_add_u32 s61, s58, 6
    s_cmp_eq_u32 s59, 0
    s_cselect_b32 s61, s61, s58
    s_mul_i32 s40, s35, 112
    s_cmp_eq_u32 s37, 0
    s_cbranch_scc0 parallel_sum__softmax_full_mha__swiglu_ffn__prompt_kernel_a_tyB
    s_add_u32 s41, s40, 896
    s_lshl_b32 s42, s60, 6
    s_mov_b32 s43, s42
    s_lshl_b32 s44, s61, 6
    s_mov_b32 s36, s61
    s_branch parallel_sum__softmax_full_mha__swiglu_ffn__prompt_kernel_a_tyC
parallel_sum__softmax_full_mha__swiglu_ffn__prompt_kernel_a_tyB:
    s_add_u32 s40, s40, 1792
    s_add_u32 s60, s60, 2
    s_lshl_b32 s41, s60, 6
    s_mov_b32 s42, s41
    s_add_u32 s43, s41, 128
    s_mov_b32 s44, s43
parallel_sum__softmax_full_mha__swiglu_ffn__prompt_kernel_a_tyC:
    s_lshl_b32 s58, s33, 2
    s_add_u32 s58, s58, s31
    s_mul_i32 s65, s58, 112
    s_lshl_b32 s71, s36, 1
    s_add_u32 s71, s71, s32
    s_add_u32 s71, s71, s65
    s_lshl_b32 s71, s71, 10
    s_add_u32 s71, s71, 6291456
    s_lshl_b32 s59, s60, 1
    s_add_u32 s65, s65, s59
    s_lshl_b32 s59, s32, 1
    s_add_u32 s65, s65, s59
    s_lshl_b32 s65, s65, 10
    s_add_u32 s65, s65, 6291456
    s_lshl_b32 s59, s35, 1
    s_add_u32 s59, s59, s32
    s_lshl_b32 s59, s59, 6
    s_add_u32 s59, s59, s58
    s_lshl_b32 s61, s59, 12
    s_add_u32 s64, s61, 2099200
    s_add_u32 s63, s61, 2097152
    s_lshl_b32 s62, s59, 11
    s_add_u32 s62, s62, 0
    s_mov_b32 s66, 0x3e8b97f6
    s_mov_b32 s67, 0
    s_mul_i32 s45, s30, 21504
    s_mul_i32 s46, s30, 28672
    s_lshl_b32 s49, s30, 10
    s_cmp_lt_u32 s30, 6
    s_cselect_b32 s51, 172032, 0
    s_cselect_b32 s52, 229376, 0
    s_cselect_b32 s58, 8192, 0
    s_add_u32 s50, s49, s58
    s_and_b32 s59, s30, 1
    s_cmp_eq_u32 s59, 0
    s_cselect_b32 s24, s12, s16
    s_cselect_b32 s25, s13, s17
    s_mov_b32 s26, 1605632
    s_mov_b32 s27, 0x20000
    s_lshr_b32 s60, s30, 1
    s_mul_i32 s53, s60, 57344
    s_mul_i32 s6, s59, 7168
    s_lshl_b32 s60, s60, 10
    s_add_u32 s6, s6, s60
    s_lshr_b32 s58, s58, 1
    s_add_u32 s7, s6, s58
    v_lshrrev_b32 v18, 2, v20
    v_mul_u32_u24 v39, 3584, v18
    v_and_b32 v18, 3, v20
    v_lshlrev_b32 v18, 4, v18
    s_lshl_b32 s59, s59, 5
    v_xor_b32 v18, s59, v18
    v_add_u32 v39, v39, v18
    v_bfe_u32 v18, v20, 2, 2
    v_lshlrev_b32 v19, 3, v22
    v_add_u32 v18, v18, v19
    v_lshlrev_b32 v36, 6, v18
    v_and_b32 v18, 3, v20
    v_lshlrev_b32 v18, 3, v18
    v_add_u32 v36, v36, v18
    v_bfe_u32 v18, v20, 4, 1
    v_mul_u32_u24 v19, 7168, v18
    v_add_u32 v36, v36, v19
    v_xor_b32 v18, s32, v18
    v_lshlrev_b32 v18, 5, v18
    v_add_u32 v36, v36, v18
    v_add_u32 v37, 57344, v36
    v_add_u32 v38, 114688, v36
    v_bfe_u32 v18, v20, 4, 1
    v_lshlrev_b32 v18, 2, v18
    v_and_b32 v19, 7, v20
    v_xor_b32 v18, v18, v19
    v_lshlrev_b32 v18, 4, v18
    v_lshrrev_b32 v19, 3, v20
    v_mul_u32_u24 v8, 2688, v19
    v_add_u32 v8, v8, v18
    v_mul_u32_u24 v9, 3584, v19
    v_add_u32 v9, v9, v18
    s_mov_b32 s54, 0
    s_mov_b32 s55, -1
    s_mov_b32 s56, 0xf0000000
    s_mov_b32 s57, 0xf0000000
    v_bfe_u32 v18, v20, 2, 2
    v_lshlrev_b32 v19, 3, v22
    v_add_u32 v19, v19, v18
    v_lshlrev_b32 v2, 7, v19
    v_bfe_u32 v19, v20, 4, 1
    v_lshlrev_b32 v19, 5, v19
    v_and_b32 v23, 3, v20
    v_lshlrev_b32 v23, 3, v23
    v_add_u32 v19, v19, v23
    s_mul_i32 s58, s32, 56
    v_add_u32 v19, s58, v19
    v_lshrrev_b32 v18, 1, v18
    v_lshlrev_b32 v18, 6, v18
    v_xor_b32 v19, v19, v18
    v_add_u32 v2, v2, v19
    v_add_u32 v3, 57344, v2
    v_add_u32 v4, 114688, v2
    v_bfe_u32 v18, v20, 2, 2
    v_lshlrev_b32 v19, 3, v22
    v_add_u32 v19, v19, v18
    v_lshlrev_b32 v5, 7, v19
    v_bfe_u32 v19, v20, 4, 1
    v_lshlrev_b32 v19, 5, v19
    v_and_b32 v23, 3, v20
    v_lshlrev_b32 v23, 3, v23
    v_add_u32 v19, v19, v23
    s_mul_i32 s58, s32, 64
    v_add_u32 v19, s58, v19
    v_lshrrev_b32 v18, 1, v18
    v_lshlrev_b32 v18, 6, v18
    v_xor_b32 v19, v19, v18
    v_add_u32 v5, v5, v19
    v_add_u32 v6, 57344, v5
    v_add_u32 v7, 114688, v5
    v_cmp_eq_u32 vcc, 28, v21
    v_mov_b32 v28, 0
    v_mov_b32 v18, 0x3f803f80
    v_cndmask_b32 v28, v28, v18, vcc
    s_lshl_b32 s58, s31, 12
    v_lshlrev_b32 v18, 7, v21
    v_add_u32 v18, s58, v18
    v_bfe_u32 v19, v21, 1, 3
    v_xor_b32 v19, v19, v22
    v_xor_b32 v23, 0, v19
    v_lshlrev_b32 v23, 4, v23
    v_add_u32 v240, v18, v23
    v_xor_b32 v23, 2, v19
    v_lshlrev_b32 v23, 4, v23
    v_add_u32 v241, v18, v23
    v_xor_b32 v23, 4, v19
    v_lshlrev_b32 v23, 4, v23
    v_add_u32 v242, v18, v23
    v_xor_b32 v23, 6, v19
    v_lshlrev_b32 v23, 4, v23
    v_add_u32 v243, v18, v23
    s_lshl_b32 s75, s33, 4
    s_add_u32 s75, s75, s34
    v_lshrrev_b32 v18, 4, v20
    v_and_b32 v19, 7, v20
    v_xor_b32 v18, v18, v19
    v_lshlrev_b32 v18, 4, v18
    v_lshrrev_b32 v19, 3, v20
    v_lshlrev_b32 v19, 7, v19
    s_waitcnt vmcnt(0)
    v_add_u32 v252, v18, v19
    v_mov_b32 v246, 0x3f803f80
    v_mov_b32 v247, 0x3f803f80
    s_mov_b32 s72, 0x22222222
    s_mov_b32 s73, 0x22222222
    s_mov_b32 s76, 0x44444444
    s_mov_b32 s77, 0x44444444
    s_mov_b32 s78, 0x88888888
    s_mov_b32 s79, 0x88888888
    s_nop 0
    v_readfirstlane_b32 s3, v26
    s_nop 0
    s_cmp_lg_u32 s3, 0
    s_cbranch_scc1 parallel_sum__softmax_full_mha__swiglu_ffn__prompt_kernel_a_taggot
    s_mov_b32 s58, 0x100000
parallel_sum__softmax_full_mha__swiglu_ffn__prompt_kernel_a_tagpoll:
    global_load_dword v26, v27, s[100:101] sc1
    s_waitcnt vmcnt(0)
    v_readfirstlane_b32 s3, v26
    s_nop 0
    s_cmp_lg_u32 s3, 0
    s_cbranch_scc1 parallel_sum__softmax_full_mha__swiglu_ffn__prompt_kernel_a_taggot
    s_sub_u32 s58, s58, 1
    s_cmp_lg_u32 s58, 0
    s_cbranch_scc1 parallel_sum__softmax_full_mha__swiglu_ffn__prompt_kernel_a_tagpoll
parallel_sum__softmax_full_mha__swiglu_ffn__prompt_kernel_a_taggot:
    s_cmp_lt_u32 s30, 4
    s_cbranch_scc1 parallel_sum__softmax_full_mha__swiglu_ffn__prompt_kernel_a_lnA
    s_add_u32 s47, s40, s45
    s_add_u32 s48, s47, s51
    s_add_u32 m0, s49, 114688
    s_add_u32 s61, s50, 114688
    buffer_load_dwordx4 v8, s[8:11], s47 offen lds
    s_mov_b32 m0, s61
    s_add_u32 s47, s47, 301056
    buffer_load_dwordx4 v8, s[8:11], s48 offen lds
    s_add_u32 s48, s48, 301056
    s_add_u32 m0, s49, 129024
    s_add_u32 s61, s50, 129024
    buffer_load_dwordx4 v8, s[8:11], s47 offen lds
    s_mov_b32 m0, s61
    s_add_u32 s47, s47, 301056
    buffer_load_dwordx4 v8, s[8:11], s48 offen lds
    s_add_u32 s48, s48, 301056
    s_branch parallel_sum__softmax_full_mha__swiglu_ffn__prompt_kernel_a_lnB
parallel_sum__softmax_full_mha__swiglu_ffn__prompt_kernel_a_lnA:
    s_lshl_b32 s58, s30, 11
    v_add_u32 v244, s58, v1
    v_add_u32 v248, s58, v252
    v_xor_b32 v249, 64, v248
    v_add_u32 v249, 1024, v249
    v_add_u32 v245, 0x10000, v244
    ds_read_b128 v[40:43], v244 offset:0
    ds_read_b128 v[68:71], v244 offset:1024
    ds_read_b128 v[44:47], v244 offset:16384
    ds_read_b128 v[72:75], v244 offset:17408
    ds_read_b128 v[48:51], v244 offset:32768
    ds_read_b128 v[76:79], v244 offset:33792
    ds_read_b128 v[52:55], v244 offset:49152
    ds_read_b128 v[80:83], v244 offset:50176
    ds_read_b128 v[56:59], v245 offset:0
    ds_read_b128 v[84:87], v245 offset:1024
    ds_read_b128 v[60:63], v245 offset:16384
    ds_read_b128 v[88:91], v245 offset:17408
    ds_read_b128 v[64:67], v245 offset:32768
    ds_read_b128 v[92:95], v245 offset:33792
    s_waitcnt lgkmcnt(13)
    v_mfma_f32_4x4x4_16b_bf16 v[96:99], v[40:41], v[246:247], 0
    v_mfma_f32_4x4x4_16b_bf16 v[104:107], v[40:41], v[40:41], 0
    s_waitcnt lgkmcnt(12)
    v_mfma_f32_4x4x4_16b_bf16 v[100:103], v[68:69], v[246:247], 0
    v_mfma_f32_4x4x4_16b_bf16 v[108:111], v[68:69], v[68:69], 0
    v_lshlrev_b32 v128, 16, v40
    v_and_b32 v129, 0xffff0000, v40
    v_lshlrev_b32 v130, 16, v41
    v_and_b32 v131, 0xffff0000, v41
    v_lshlrev_b32 v184, 16, v68
    v_and_b32 v185, 0xffff0000, v68
    v_lshlrev_b32 v186, 16, v69
    v_and_b32 v187, 0xffff0000, v69
    v_mfma_f32_4x4x4_16b_bf16 v[96:99], v[42:43], v[246:247], v[96:99]
    v_mfma_f32_4x4x4_16b_bf16 v[104:107], v[42:43], v[42:43], v[104:107]
    v_mfma_f32_4x4x4_16b_bf16 v[100:103], v[70:71], v[246:247], v[100:103]
    v_mfma_f32_4x4x4_16b_bf16 v[108:111], v[70:71], v[70:71], v[108:111]
    v_lshlrev_b32 v132, 16, v42
    v_and_b32 v133, 0xffff0000, v42
    v_lshlrev_b32 v134, 16, v43
    v_and_b32 v135, 0xffff0000, v43
    v_lshlrev_b32 v188, 16, v70
    v_and_b32 v189, 0xffff0000, v70
    v_lshlrev_b32 v190, 16, v71
    v_and_b32 v191, 0xffff0000, v71
    s_waitcnt lgkmcnt(11)
    v_mfma_f32_4x4x4_16b_bf16 v[96:99], v[44:45], v[246:247], v[96:99]
    v_mfma_f32_4x4x4_16b_bf16 v[104:107], v[44:45], v[44:45], v[104:107]
    s_waitcnt lgkmcnt(10)
    v_mfma_f32_4x4x4_16b_bf16 v[100:103], v[72:73], v[246:247], v[100:103]
    v_mfma_f32_4x4x4_16b_bf16 v[108:111], v[72:73], v[72:73], v[108:111]
    v_lshlrev_b32 v136, 16, v44
    v_and_b32 v137, 0xffff0000, v44
    v_lshlrev_b32 v138, 16, v45
    v_and_b32 v139, 0xffff0000, v45
    v_lshlrev_b32 v192, 16, v72
    v_and_b32 v193, 0xffff0000, v72
    v_lshlrev_b32 v194, 16, v73
    v_and_b32 v195, 0xffff0000, v73
    v_mfma_f32_4x4x4_16b_bf16 v[96:99], v[46:47], v[246:247], v[96:99]
    v_mfma_f32_4x4x4_16b_bf16 v[104:107], v[46:47], v[46:47], v[104:107]
    v_mfma_f32_4x4x4_16b_bf16 v[100:103], v[74:75], v[246:247], v[100:103]
    v_mfma_f32_4x4x4_16b_bf16 v[108:111], v[74:75], v[74:75], v[108:111]
    v_lshlrev_b32 v140, 16, v46
    v_and_b32 v141, 0xffff0000, v46
    v_lshlrev_b32 v142, 16, v47
    v_and_b32 v143, 0xffff0000, v47
    v_lshlrev_b32 v196, 16, v74
    v_and_b32 v197, 0xffff0000, v74
    v_lshlrev_b32 v198, 16, v75
    v_and_b32 v199, 0xffff0000, v75
    s_waitcnt lgkmcnt(9)
    v_mfma_f32_4x4x4_16b_bf16 v[96:99], v[48:49], v[246:247], v[96:99]
    v_mfma_f32_4x4x4_16b_bf16 v[104:107], v[48:49], v[48:49], v[104:107]
    s_waitcnt lgkmcnt(8)
    v_mfma_f32_4x4x4_16b_bf16 v[100:103], v[76:77], v[246:247], v[100:103]
    v_mfma_f32_4x4x4_16b_bf16 v[108:111], v[76:77], v[76:77], v[108:111]
    v_lshlrev_b32 v144, 16, v48
    v_and_b32 v145, 0xffff0000, v48
    v_lshlrev_b32 v146, 16, v49
    v_and_b32 v147, 0xffff0000, v49
    v_lshlrev_b32 v200, 16, v76
    v_and_b32 v201, 0xffff0000, v76
    v_lshlrev_b32 v202, 16, v77
    v_and_b32 v203, 0xffff0000, v77
    v_mfma_f32_4x4x4_16b_bf16 v[96:99], v[50:51], v[246:247], v[96:99]
    v_mfma_f32_4x4x4_16b_bf16 v[104:107], v[50:51], v[50:51], v[104:107]
    v_mfma_f32_4x4x4_16b_bf16 v[100:103], v[78:79], v[246:247], v[100:103]
    v_mfma_f32_4x4x4_16b_bf16 v[108:111], v[78:79], v[78:79], v[108:111]
    v_lshlrev_b32 v148, 16, v50
    v_and_b32 v149, 0xffff0000, v50
    v_lshlrev_b32 v150, 16, v51
    v_and_b32 v151, 0xffff0000, v51
    v_lshlrev_b32 v204, 16, v78
    v_and_b32 v205, 0xffff0000, v78
    v_lshlrev_b32 v206, 16, v79
    v_and_b32 v207, 0xffff0000, v79
    s_waitcnt lgkmcnt(7)
    v_mfma_f32_4x4x4_16b_bf16 v[96:99], v[52:53], v[246:247], v[96:99]
    v_mfma_f32_4x4x4_16b_bf16 v[104:107], v[52:53], v[52:53], v[104:107]
    s_waitcnt lgkmcnt(6)
    v_mfma_f32_4x4x4_16b_bf16 v[100:103], v[80:81], v[246:247], v[100:103]
    v_mfma_f32_4x4x4_16b_bf16 v[108:111], v[80:81], v[80:81], v[108:111]
    v_lshlrev_b32 v152, 16, v52
    v_and_b32 v153, 0xffff0000, v52
    v_lshlrev_b32 v154, 16, v53
    v_and_b32 v155, 0xffff0000, v53
    v_lshlrev_b32 v208, 16, v80
    v_and_b32 v209, 0xffff0000, v80
    v_lshlrev_b32 v210, 16, v81
    v_and_b32 v211, 0xffff0000, v81
    v_mfma_f32_4x4x4_16b_bf16 v[96:99], v[54:55], v[246:247], v[96:99]
    v_mfma_f32_4x4x4_16b_bf16 v[104:107], v[54:55], v[54:55], v[104:107]
    v_mfma_f32_4x4x4_16b_bf16 v[100:103], v[82:83], v[246:247], v[100:103]
    v_mfma_f32_4x4x4_16b_bf16 v[108:111], v[82:83], v[82:83], v[108:111]
    v_lshlrev_b32 v156, 16, v54
    v_and_b32 v157, 0xffff0000, v54
    v_lshlrev_b32 v158, 16, v55
    v_and_b32 v159, 0xffff0000, v55
    v_lshlrev_b32 v212, 16, v82
    v_and_b32 v213, 0xffff0000, v82
    v_lshlrev_b32 v214, 16, v83
    v_and_b32 v215, 0xffff0000, v83
    s_waitcnt lgkmcnt(5)
    v_mfma_f32_4x4x4_16b_bf16 v[96:99], v[56:57], v[246:247], v[96:99]
    v_mfma_f32_4x4x4_16b_bf16 v[104:107], v[56:57], v[56:57], v[104:107]
    s_waitcnt lgkmcnt(4)
    v_mfma_f32_4x4x4_16b_bf16 v[100:103], v[84:85], v[246:247], v[100:103]
    v_mfma_f32_4x4x4_16b_bf16 v[108:111], v[84:85], v[84:85], v[108:111]
    v_lshlrev_b32 v160, 16, v56
    v_and_b32 v161, 0xffff0000, v56
    v_lshlrev_b32 v162, 16, v57
    v_and_b32 v163, 0xffff0000, v57
    v_lshlrev_b32 v216, 16, v84
    v_and_b32 v217, 0xffff0000, v84
    v_lshlrev_b32 v218, 16, v85
    v_and_b32 v219, 0xffff0000, v85
    v_mfma_f32_4x4x4_16b_bf16 v[96:99], v[58:59], v[246:247], v[96:99]
    v_mfma_f32_4x4x4_16b_bf16 v[104:107], v[58:59], v[58:59], v[104:107]
    v_mfma_f32_4x4x4_16b_bf16 v[100:103], v[86:87], v[246:247], v[100:103]
    v_mfma_f32_4x4x4_16b_bf16 v[108:111], v[86:87], v[86:87], v[108:111]
    v_lshlrev_b32 v164, 16, v58
    v_and_b32 v165, 0xffff0000, v58
    v_lshlrev_b32 v166, 16, v59
    v_and_b32 v167, 0xffff0000, v59
    v_lshlrev_b32 v220, 16, v86
    v_and_b32 v221, 0xffff0000, v86
    v_lshlrev_b32 v222, 16, v87
    v_and_b32 v223, 0xffff0000, v87
    s_waitcnt lgkmcnt(3)
    v_mfma_f32_4x4x4_16b_bf16 v[96:99], v[60:61], v[246:247], v[96:99]
    v_mfma_f32_4x4x4_16b_bf16 v[104:107], v[60:61], v[60:61], v[104:107]
    s_waitcnt lgkmcnt(2)
    v_mfma_f32_4x4x4_16b_bf16 v[100:103], v[88:89], v[246:247], v[100:103]
    v_mfma_f32_4x4x4_16b_bf16 v[108:111], v[88:89], v[88:89], v[108:111]
    v_lshlrev_b32 v168, 16, v60
    v_and_b32 v169, 0xffff0000, v60
    v_lshlrev_b32 v170, 16, v61
    v_and_b32 v171, 0xffff0000, v61
    v_lshlrev_b32 v224, 16, v88
    v_and_b32 v225, 0xffff0000, v88
    v_lshlrev_b32 v226, 16, v89
    v_and_b32 v227, 0xffff0000, v89
    v_mfma_f32_4x4x4_16b_bf16 v[96:99], v[62:63], v[246:247], v[96:99]
    v_mfma_f32_4x4x4_16b_bf16 v[104:107], v[62:63], v[62:63], v[104:107]
    v_mfma_f32_4x4x4_16b_bf16 v[100:103], v[90:91], v[246:247], v[100:103]
    v_mfma_f32_4x4x4_16b_bf16 v[108:111], v[90:91], v[90:91], v[108:111]
    v_lshlrev_b32 v172, 16, v62
    v_and_b32 v173, 0xffff0000, v62
    v_lshlrev_b32 v174, 16, v63
    v_and_b32 v175, 0xffff0000, v63
    v_lshlrev_b32 v228, 16, v90
    v_and_b32 v229, 0xffff0000, v90
    v_lshlrev_b32 v230, 16, v91
    v_and_b32 v231, 0xffff0000, v91
    s_waitcnt lgkmcnt(1)
    v_mfma_f32_4x4x4_16b_bf16 v[96:99], v[64:65], v[246:247], v[96:99]
    v_mfma_f32_4x4x4_16b_bf16 v[104:107], v[64:65], v[64:65], v[104:107]
    s_waitcnt lgkmcnt(0)
    v_mfma_f32_4x4x4_16b_bf16 v[100:103], v[92:93], v[246:247], v[100:103]
    v_mfma_f32_4x4x4_16b_bf16 v[108:111], v[92:93], v[92:93], v[108:111]
    v_lshlrev_b32 v176, 16, v64
    v_and_b32 v177, 0xffff0000, v64
    v_lshlrev_b32 v178, 16, v65
    v_and_b32 v179, 0xffff0000, v65
    v_lshlrev_b32 v232, 16, v92
    v_and_b32 v233, 0xffff0000, v92
    v_lshlrev_b32 v234, 16, v93
    v_and_b32 v235, 0xffff0000, v93
    v_mfma_f32_4x4x4_16b_bf16 v[96:99], v[66:67], v[246:247], v[96:99]
    v_mfma_f32_4x4x4_16b_bf16 v[104:107], v[66:67], v[66:67], v[104:107]
    v_mfma_f32_4x4x4_16b_bf16 v[100:103], v[94:95], v[246:247], v[100:103]
    v_mfma_f32_4x4x4_16b_bf16 v[108:111], v[94:95], v[94:95], v[108:111]
    v_lshlrev_b32 v180, 16, v66
    v_and_b32 v181, 0xffff0000, v66
    v_lshlrev_b32 v182, 16, v67
    v_and_b32 v183, 0xffff0000, v67
    v_lshlrev_b32 v236, 16, v94
    v_and_b32 v237, 0xffff0000, v94
    v_lshlrev_b32 v238, 16, v95
    v_and_b32 v239, 0xffff0000, v95
    v_cndmask_b32 v96, v96, v97, s[72:73]
    v_cndmask_b32 v96, v96, v98, s[76:77]
    v_cndmask_b32 v96, v96, v99, s[78:79]
    v_cndmask_b32 v100, v100, v101, s[72:73]
    v_cndmask_b32 v100, v100, v102, s[76:77]
    v_cndmask_b32 v100, v100, v103, s[78:79]
    v_cndmask_b32 v104, v104, v105, s[72:73]
    v_cndmask_b32 v104, v104, v106, s[76:77]
    v_cndmask_b32 v104, v104, v107, s[78:79]
    v_cndmask_b32 v108, v108, v109, s[72:73]
    v_cndmask_b32 v108, v108, v110, s[76:77]
    v_cndmask_b32 v108, v108, v111, s[78:79]
    v_add_f32_dpp v96, v96, v96 quad_perm:[1,0,3,2] row_mask:0xf bank_mask:0xf
    v_add_f32_dpp v100, v100, v100 quad_perm:[1,0,3,2] row_mask:0xf bank_mask:0xf
    v_add_f32_dpp v104, v104, v104 quad_perm:[1,0,3,2] row_mask:0xf bank_mask:0xf
    v_add_f32_dpp v108, v108, v108 quad_perm:[1,0,3,2] row_mask:0xf bank_mask:0xf
    v_add_f32_dpp v96, v96, v96 quad_perm:[2,3,0,1] row_mask:0xf bank_mask:0xf
    v_add_f32_dpp v100, v100, v100 quad_perm:[2,3,0,1] row_mask:0xf bank_mask:0xf
    v_add_f32_dpp v104, v104, v104 quad_perm:[2,3,0,1] row_mask:0xf bank_mask:0xf
    v_add_f32_dpp v108, v108, v108 quad_perm:[2,3,0,1] row_mask:0xf bank_mask:0xf
    v_add_f32_dpp v96, v96, v96 row_half_mirror row_mask:0xf bank_mask:0xf
    v_add_f32_dpp v100, v100, v100 row_half_mirror row_mask:0xf bank_mask:0xf
    v_add_f32_dpp v104, v104, v104 row_half_mirror row_mask:0xf bank_mask:0xf
    v_add_f32_dpp v108, v108, v108 row_half_mirror row_mask:0xf bank_mask:0xf
    v_mul_f32 v96, 0x3b124925, v96
    v_mul_f32 v104, 0x3b124925, v104
    v_fma_f32 v104, -v96, v96, v104
    v_max_f32 v104, 0, v104
    v_add_f32 v104, 0x3727c5ac, v104
    v_rsq_f32 v104, v104
    v_mul_f32 v100, 0x3b124925, v100
    v_mul_f32 v108, 0x3b124925, v108
    v_fma_f32 v108, -v100, v100, v108
    v_max_f32 v108, 0, v108
    v_add_f32 v108, 0x3727c5ac, v108
    v_rsq_f32 v108, v108
    v_mul_f32 v96, v96, v104
    v_sub_f32 v96, 0, v96
    v_mul_f32 v100, v100, v108
    v_sub_f32 v100, 0, v100
    v_pk_fma_f32 v[128:129], v[128:129], v[104:105], v[96:97] op_sel_hi:[1,0,0]
    v_pk_fma_f32 v[130:131], v[130:131], v[104:105], v[96:97] op_sel_hi:[1,0,0]
    v_pk_fma_f32 v[132:133], v[132:133], v[104:105], v[96:97] op_sel_hi:[1,0,0]
    v_pk_fma_f32 v[134:135], v[134:135], v[104:105], v[96:97] op_sel_hi:[1,0,0]
    v_cvt_pk_bf16_f32 v40, v128, v129
    v_cvt_pk_bf16_f32 v41, v130, v131
    v_cvt_pk_bf16_f32 v42, v132, v133
    v_cvt_pk_bf16_f32 v43, v134, v135
    ds_write_b128 v248, v[40:43] offset:0
    v_pk_fma_f32 v[184:185], v[184:185], v[108:109], v[100:101] op_sel_hi:[1,0,0]
    v_pk_fma_f32 v[186:187], v[186:187], v[108:109], v[100:101] op_sel_hi:[1,0,0]
    v_pk_fma_f32 v[188:189], v[188:189], v[108:109], v[100:101] op_sel_hi:[1,0,0]
    v_pk_fma_f32 v[190:191], v[190:191], v[108:109], v[100:101] op_sel_hi:[1,0,0]
    v_cvt_pk_bf16_f32 v68, v184, v185
    v_cvt_pk_bf16_f32 v69, v186, v187
    v_cvt_pk_bf16_f32 v70, v188, v189
    v_cvt_pk_bf16_f32 v71, v190, v191
    ds_write_b128 v249, v[68:71] offset:0
    v_pk_fma_f32 v[136:137], v[136:137], v[104:105], v[96:97] op_sel_hi:[1,0,0]
    v_pk_fma_f32 v[138:139], v[138:139], v[104:105], v[96:97] op_sel_hi:[1,0,0]
    v_pk_fma_f32 v[140:141], v[140:141], v[104:105], v[96:97] op_sel_hi:[1,0,0]
    v_pk_fma_f32 v[142:143], v[142:143], v[104:105], v[96:97] op_sel_hi:[1,0,0]
    v_cvt_pk_bf16_f32 v44, v136, v137
    v_cvt_pk_bf16_f32 v45, v138, v139
    v_cvt_pk_bf16_f32 v46, v140, v141
    v_cvt_pk_bf16_f32 v47, v142, v143
    ds_write_b128 v248, v[44:47] offset:16384
    v_pk_fma_f32 v[192:193], v[192:193], v[108:109], v[100:101] op_sel_hi:[1,0,0]
    v_pk_fma_f32 v[194:195], v[194:195], v[108:109], v[100:101] op_sel_hi:[1,0,0]
    v_pk_fma_f32 v[196:197], v[196:197], v[108:109], v[100:101] op_sel_hi:[1,0,0]
    v_pk_fma_f32 v[198:199], v[198:199], v[108:109], v[100:101] op_sel_hi:[1,0,0]
    v_cvt_pk_bf16_f32 v72, v192, v193
    v_cvt_pk_bf16_f32 v73, v194, v195
    v_cvt_pk_bf16_f32 v74, v196, v197
    v_cvt_pk_bf16_f32 v75, v198, v199
    ds_write_b128 v249, v[72:75] offset:16384
    v_pk_fma_f32 v[144:145], v[144:145], v[104:105], v[96:97] op_sel_hi:[1,0,0]
    v_pk_fma_f32 v[146:147], v[146:147], v[104:105], v[96:97] op_sel_hi:[1,0,0]
    v_pk_fma_f32 v[148:149], v[148:149], v[104:105], v[96:97] op_sel_hi:[1,0,0]
    v_pk_fma_f32 v[150:151], v[150:151], v[104:105], v[96:97] op_sel_hi:[1,0,0]
    v_cvt_pk_bf16_f32 v48, v144, v145
    v_cvt_pk_bf16_f32 v49, v146, v147
    v_cvt_pk_bf16_f32 v50, v148, v149
    v_cvt_pk_bf16_f32 v51, v150, v151
    ds_write_b128 v248, v[48:51] offset:32768
    v_pk_fma_f32 v[200:201], v[200:201], v[108:109], v[100:101] op_sel_hi:[1,0,0]
    v_pk_fma_f32 v[202:203], v[202:203], v[108:109], v[100:101] op_sel_hi:[1,0,0]
    v_pk_fma_f32 v[204:205], v[204:205], v[108:109], v[100:101] op_sel_hi:[1,0,0]
    v_pk_fma_f32 v[206:207], v[206:207], v[108:109], v[100:101] op_sel_hi:[1,0,0]
    v_cvt_pk_bf16_f32 v76, v200, v201
    v_cvt_pk_bf16_f32 v77, v202, v203
    v_cvt_pk_bf16_f32 v78, v204, v205
    v_cvt_pk_bf16_f32 v79, v206, v207
    ds_write_b128 v249, v[76:79] offset:32768
    v_pk_fma_f32 v[152:153], v[152:153], v[104:105], v[96:97] op_sel_hi:[1,0,0]
    v_pk_fma_f32 v[154:155], v[154:155], v[104:105], v[96:97] op_sel_hi:[1,0,0]
    v_pk_fma_f32 v[156:157], v[156:157], v[104:105], v[96:97] op_sel_hi:[1,0,0]
    v_pk_fma_f32 v[158:159], v[158:159], v[104:105], v[96:97] op_sel_hi:[1,0,0]
    v_cvt_pk_bf16_f32 v52, v152, v153
    v_cvt_pk_bf16_f32 v53, v154, v155
    v_cvt_pk_bf16_f32 v54, v156, v157
    v_cvt_pk_bf16_f32 v55, v158, v159
    ds_write_b128 v248, v[52:55] offset:49152
    v_pk_fma_f32 v[208:209], v[208:209], v[108:109], v[100:101] op_sel_hi:[1,0,0]
    v_pk_fma_f32 v[210:211], v[210:211], v[108:109], v[100:101] op_sel_hi:[1,0,0]
    v_pk_fma_f32 v[212:213], v[212:213], v[108:109], v[100:101] op_sel_hi:[1,0,0]
    v_pk_fma_f32 v[214:215], v[214:215], v[108:109], v[100:101] op_sel_hi:[1,0,0]
    v_cvt_pk_bf16_f32 v80, v208, v209
    v_cvt_pk_bf16_f32 v81, v210, v211
    v_cvt_pk_bf16_f32 v82, v212, v213
    v_cvt_pk_bf16_f32 v83, v214, v215
    ds_write_b128 v249, v[80:83] offset:49152
    s_add_u32 s47, s40, s45
    s_add_u32 s48, s47, s51
    s_add_u32 m0, s49, 114688
    s_add_u32 s61, s50, 114688
    buffer_load_dwordx4 v8, s[8:11], s47 offen lds
    s_mov_b32 m0, s61
    s_add_u32 s47, s47, 301056
    buffer_load_dwordx4 v8, s[8:11], s48 offen lds
    s_add_u32 s48, s48, 301056
    s_add_u32 m0, s49, 129024
    s_add_u32 s61, s50, 129024
    buffer_load_dwordx4 v8, s[8:11], s47 offen lds
    s_mov_b32 m0, s61
    s_add_u32 s47, s47, 301056
    buffer_load_dwordx4 v8, s[8:11], s48 offen lds
    s_add_u32 s48, s48, 301056
    v_pk_fma_f32 v[160:161], v[160:161], v[104:105], v[96:97] op_sel_hi:[1,0,0]
    v_pk_fma_f32 v[162:163], v[162:163], v[104:105], v[96:97] op_sel_hi:[1,0,0]
    v_pk_fma_f32 v[164:165], v[164:165], v[104:105], v[96:97] op_sel_hi:[1,0,0]
    v_pk_fma_f32 v[166:167], v[166:167], v[104:105], v[96:97] op_sel_hi:[1,0,0]
    v_cvt_pk_bf16_f32 v56, v160, v161
    v_cvt_pk_bf16_f32 v57, v162, v163
    v_cvt_pk_bf16_f32 v58, v164, v165
    v_cvt_pk_bf16_f32 v59, v166, v167
    v_add_u32 v248, 0x10000, v248
    v_add_u32 v249, 0x10000, v249
    ds_write_b128 v248, v[56:59] offset:0
    v_pk_fma_f32 v[216:217], v[216:217], v[108:109], v[100:101] op_sel_hi:[1,0,0]
    v_pk_fma_f32 v[218:219], v[218:219], v[108:109], v[100:101] op_sel_hi:[1,0,0]
    v_pk_fma_f32 v[220:221], v[220:221], v[108:109], v[100:101] op_sel_hi:[1,0,0]
    v_pk_fma_f32 v[222:223], v[222:223], v[108:109], v[100:101] op_sel_hi:[1,0,0]
    v_cvt_pk_bf16_f32 v84, v216, v217
    v_cvt_pk_bf16_f32 v85, v218, v219
    v_cvt_pk_bf16_f32 v86, v220, v221
    v_cvt_pk_bf16_f32 v87, v222, v223
    ds_write_b128 v249, v[84:87] offset:0
    v_pk_fma_f32 v[168:169], v[168:169], v[104:105], v[96:97] op_sel_hi:[1,0,0]
    v_pk_fma_f32 v[170:171], v[170:171], v[104:105], v[96:97] op_sel_hi:[1,0,0]
    v_pk_fma_f32 v[172:173], v[172:173], v[104:105], v[96:97] op_sel_hi:[1,0,0]
    v_pk_fma_f32 v[174:175], v[174:175], v[104:105], v[96:97] op_sel_hi:[1,0,0]
    v_cvt_pk_bf16_f32 v60, v168, v169
    v_cvt_pk_bf16_f32 v61, v170, v171
    v_cvt_pk_bf16_f32 v62, v172, v173
    v_cvt_pk_bf16_f32 v63, v174, v175
    ds_write_b128 v248, v[60:63] offset:16384
    v_pk_fma_f32 v[224:225], v[224:225], v[108:109], v[100:101] op_sel_hi:[1,0,0]
    v_pk_fma_f32 v[226:227], v[226:227], v[108:109], v[100:101] op_sel_hi:[1,0,0]
    v_pk_fma_f32 v[228:229], v[228:229], v[108:109], v[100:101] op_sel_hi:[1,0,0]
    v_pk_fma_f32 v[230:231], v[230:231], v[108:109], v[100:101] op_sel_hi:[1,0,0]
    v_cvt_pk_bf16_f32 v88, v224, v225
    v_cvt_pk_bf16_f32 v89, v226, v227
    v_cvt_pk_bf16_f32 v90, v228, v229
    v_cvt_pk_bf16_f32 v91, v230, v231
    ds_write_b128 v249, v[88:91] offset:16384
    v_pk_fma_f32 v[176:177], v[176:177], v[104:105], v[96:97] op_sel_hi:[1,0,0]
    v_pk_fma_f32 v[178:179], v[178:179], v[104:105], v[96:97] op_sel_hi:[1,0,0]
    v_pk_fma_f32 v[180:181], v[180:181], v[104:105], v[96:97] op_sel_hi:[1,0,0]
    v_pk_fma_f32 v[182:183], v[182:183], v[104:105], v[96:97] op_sel_hi:[1,0,0]
    v_cvt_pk_bf16_f32 v64, v176, v177
    v_cvt_pk_bf16_f32 v65, v178, v179
    v_cvt_pk_bf16_f32 v66, v180, v181
    v_cvt_pk_bf16_f32 v67, v182, v183
    ds_write_b128 v248, v[64:67] offset:32768
    v_pk_fma_f32 v[232:233], v[232:233], v[108:109], v[100:101] op_sel_hi:[1,0,0]
    v_pk_fma_f32 v[234:235], v[234:235], v[108:109], v[100:101] op_sel_hi:[1,0,0]
    v_pk_fma_f32 v[236:237], v[236:237], v[108:109], v[100:101] op_sel_hi:[1,0,0]
    v_pk_fma_f32 v[238:239], v[238:239], v[108:109], v[100:101] op_sel_hi:[1,0,0]
    v_cvt_pk_bf16_f32 v92, v232, v233
    v_cvt_pk_bf16_f32 v93, v234, v235
    v_cvt_pk_bf16_f32 v94, v236, v237
    v_cvt_pk_bf16_f32 v95, v238, v239
    ds_write_b128 v249, v[92:95] offset:32768
parallel_sum__softmax_full_mha__swiglu_ffn__prompt_kernel_a_lnB:
    s_barrier
    s_add_u32 s58, s30, 8
    s_lshl_b32 s58, s58, 10
    v_add_u32 v244, s58, v1
    s_and_b32 s59, s30, 1
    s_lshl_b32 s59, s59, 6
    v_xor_b32 v248, s59, v252
    v_add_u32 v248, s58, v248
    v_add_u32 v245, 0x10000, v244
    ds_read_b128 v[40:43], v244 offset:0
    ds_read_b128 v[44:47], v244 offset:16384
    ds_read_b128 v[48:51], v244 offset:32768
    ds_read_b128 v[52:55], v244 offset:49152
    ds_read_b128 v[56:59], v245 offset:0
    ds_read_b128 v[60:63], v245 offset:16384
    ds_read_b128 v[64:67], v245 offset:32768
    s_waitcnt lgkmcnt(6)
    v_mfma_f32_4x4x4_16b_bf16 v[96:99], v[40:41], v[246:247], 0
    v_mfma_f32_4x4x4_16b_bf16 v[104:107], v[40:41], v[40:41], 0
    v_lshlrev_b32 v128, 16, v40
    v_and_b32 v129, 0xffff0000, v40
    v_lshlrev_b32 v130, 16, v41
    v_and_b32 v131, 0xffff0000, v41
    v_mfma_f32_4x4x4_16b_bf16 v[96:99], v[42:43], v[246:247], v[96:99]
    v_mfma_f32_4x4x4_16b_bf16 v[104:107], v[42:43], v[42:43], v[104:107]
    v_lshlrev_b32 v132, 16, v42
    v_and_b32 v133, 0xffff0000, v42
    v_lshlrev_b32 v134, 16, v43
    v_and_b32 v135, 0xffff0000, v43
    s_waitcnt lgkmcnt(5)
    v_mfma_f32_4x4x4_16b_bf16 v[96:99], v[44:45], v[246:247], v[96:99]
    v_mfma_f32_4x4x4_16b_bf16 v[104:107], v[44:45], v[44:45], v[104:107]
    v_lshlrev_b32 v136, 16, v44
    v_and_b32 v137, 0xffff0000, v44
    v_lshlrev_b32 v138, 16, v45
    v_and_b32 v139, 0xffff0000, v45
    v_mfma_f32_4x4x4_16b_bf16 v[96:99], v[46:47], v[246:247], v[96:99]
    v_mfma_f32_4x4x4_16b_bf16 v[104:107], v[46:47], v[46:47], v[104:107]
    v_lshlrev_b32 v140, 16, v46
    v_and_b32 v141, 0xffff0000, v46
    v_lshlrev_b32 v142, 16, v47
    v_and_b32 v143, 0xffff0000, v47
    s_waitcnt lgkmcnt(4)
    v_mfma_f32_4x4x4_16b_bf16 v[96:99], v[48:49], v[246:247], v[96:99]
    v_mfma_f32_4x4x4_16b_bf16 v[104:107], v[48:49], v[48:49], v[104:107]
    v_lshlrev_b32 v144, 16, v48
    v_and_b32 v145, 0xffff0000, v48
    v_lshlrev_b32 v146, 16, v49
    v_and_b32 v147, 0xffff0000, v49
    v_mfma_f32_4x4x4_16b_bf16 v[96:99], v[50:51], v[246:247], v[96:99]
    v_mfma_f32_4x4x4_16b_bf16 v[104:107], v[50:51], v[50:51], v[104:107]
    v_lshlrev_b32 v148, 16, v50
    v_and_b32 v149, 0xffff0000, v50
    v_lshlrev_b32 v150, 16, v51
    v_and_b32 v151, 0xffff0000, v51
    s_waitcnt lgkmcnt(3)
    v_mfma_f32_4x4x4_16b_bf16 v[96:99], v[52:53], v[246:247], v[96:99]
    v_mfma_f32_4x4x4_16b_bf16 v[104:107], v[52:53], v[52:53], v[104:107]
    v_lshlrev_b32 v152, 16, v52
    v_and_b32 v153, 0xffff0000, v52
    v_lshlrev_b32 v154, 16, v53
    v_and_b32 v155, 0xffff0000, v53
    v_mfma_f32_4x4x4_16b_bf16 v[96:99], v[54:55], v[246:247], v[96:99]
    v_mfma_f32_4x4x4_16b_bf16 v[104:107], v[54:55], v[54:55], v[104:107]
    v_lshlrev_b32 v156, 16, v54
    v_and_b32 v157, 0xffff0000, v54
    v_lshlrev_b32 v158, 16, v55
    v_and_b32 v159, 0xffff0000, v55
    s_waitcnt lgkmcnt(2)
    v_mfma_f32_4x4x4_16b_bf16 v[96:99], v[56:57], v[246:247], v[96:99]
    v_mfma_f32_4x4x4_16b_bf16 v[104:107], v[56:57], v[56:57], v[104:107]
    v_lshlrev_b32 v160, 16, v56
    v_and_b32 v161, 0xffff0000, v56
    v_lshlrev_b32 v162, 16, v57
    v_and_b32 v163, 0xffff0000, v57
    v_mfma_f32_4x4x4_16b_bf16 v[96:99], v[58:59], v[246:247], v[96:99]
    v_mfma_f32_4x4x4_16b_bf16 v[104:107], v[58:59], v[58:59], v[104:107]
    v_lshlrev_b32 v164, 16, v58
    v_and_b32 v165, 0xffff0000, v58
    v_lshlrev_b32 v166, 16, v59
    v_and_b32 v167, 0xffff0000, v59
    s_waitcnt lgkmcnt(1)
    v_mfma_f32_4x4x4_16b_bf16 v[96:99], v[60:61], v[246:247], v[96:99]
    v_mfma_f32_4x4x4_16b_bf16 v[104:107], v[60:61], v[60:61], v[104:107]
    v_lshlrev_b32 v168, 16, v60
    v_and_b32 v169, 0xffff0000, v60
    v_lshlrev_b32 v170, 16, v61
    v_and_b32 v171, 0xffff0000, v61
    v_mfma_f32_4x4x4_16b_bf16 v[96:99], v[62:63], v[246:247], v[96:99]
    v_mfma_f32_4x4x4_16b_bf16 v[104:107], v[62:63], v[62:63], v[104:107]
    v_lshlrev_b32 v172, 16, v62
    v_and_b32 v173, 0xffff0000, v62
    v_lshlrev_b32 v174, 16, v63
    v_and_b32 v175, 0xffff0000, v63
    s_waitcnt lgkmcnt(0)
    v_mfma_f32_4x4x4_16b_bf16 v[96:99], v[64:65], v[246:247], v[96:99]
    v_mfma_f32_4x4x4_16b_bf16 v[104:107], v[64:65], v[64:65], v[104:107]
    v_lshlrev_b32 v176, 16, v64
    v_and_b32 v177, 0xffff0000, v64
    v_lshlrev_b32 v178, 16, v65
    v_and_b32 v179, 0xffff0000, v65
    v_mfma_f32_4x4x4_16b_bf16 v[96:99], v[66:67], v[246:247], v[96:99]
    v_mfma_f32_4x4x4_16b_bf16 v[104:107], v[66:67], v[66:67], v[104:107]
    v_lshlrev_b32 v180, 16, v66
    v_and_b32 v181, 0xffff0000, v66
    v_lshlrev_b32 v182, 16, v67
    v_and_b32 v183, 0xffff0000, v67
    v_cndmask_b32 v96, v96, v97, s[72:73]
    v_cndmask_b32 v96, v96, v98, s[76:77]
    v_cndmask_b32 v96, v96, v99, s[78:79]
    v_cndmask_b32 v104, v104, v105, s[72:73]
    v_cndmask_b32 v104, v104, v106, s[76:77]
    v_cndmask_b32 v104, v104, v107, s[78:79]
    v_add_f32_dpp v96, v96, v96 quad_perm:[1,0,3,2] row_mask:0xf bank_mask:0xf
    s_nop 0
    v_add_f32_dpp v104, v104, v104 quad_perm:[1,0,3,2] row_mask:0xf bank_mask:0xf
    v_add_f32_dpp v96, v96, v96 quad_perm:[2,3,0,1] row_mask:0xf bank_mask:0xf
    s_nop 0
    v_add_f32_dpp v104, v104, v104 quad_perm:[2,3,0,1] row_mask:0xf bank_mask:0xf
    v_add_f32_dpp v96, v96, v96 row_half_mirror row_mask:0xf bank_mask:0xf
    s_nop 0
    v_add_f32_dpp v104, v104, v104 row_half_mirror row_mask:0xf bank_mask:0xf
    v_mul_f32 v96, 0x3b124925, v96
    v_mul_f32 v104, 0x3b124925, v104
    v_fma_f32 v104, -v96, v96, v104
    v_max_f32 v104, 0, v104
    v_add_f32 v104, 0x3727c5ac, v104
    v_rsq_f32 v104, v104
    s_nop 0
    v_mul_f32 v96, v96, v104
    v_sub_f32 v96, 0, v96
    s_add_u32 m0, s49, 143360
    s_add_u32 s61, s50, 143360
    buffer_load_dwordx4 v8, s[8:11], s47 offen lds
    s_mov_b32 m0, s61
    s_add_u32 s47, s47, 301056
    buffer_load_dwordx4 v8, s[8:11], s48 offen lds
    s_add_u32 s48, s48, 301056
    v_pk_fma_f32 v[128:129], v[128:129], v[104:105], v[96:97] op_sel_hi:[1,0,0]
    v_pk_fma_f32 v[130:131], v[130:131], v[104:105], v[96:97] op_sel_hi:[1,0,0]
    v_pk_fma_f32 v[132:133], v[132:133], v[104:105], v[96:97] op_sel_hi:[1,0,0]
    v_pk_fma_f32 v[134:135], v[134:135], v[104:105], v[96:97] op_sel_hi:[1,0,0]
    v_cvt_pk_bf16_f32 v40, v128, v129
    v_cvt_pk_bf16_f32 v41, v130, v131
    v_cvt_pk_bf16_f32 v42, v132, v133
    v_cvt_pk_bf16_f32 v43, v134, v135
    ds_write_b128 v248, v[40:43] offset:0
    v_pk_fma_f32 v[136:137], v[136:137], v[104:105], v[96:97] op_sel_hi:[1,0,0]
    v_pk_fma_f32 v[138:139], v[138:139], v[104:105], v[96:97] op_sel_hi:[1,0,0]
    v_pk_fma_f32 v[140:141], v[140:141], v[104:105], v[96:97] op_sel_hi:[1,0,0]
    v_pk_fma_f32 v[142:143], v[142:143], v[104:105], v[96:97] op_sel_hi:[1,0,0]
    v_cvt_pk_bf16_f32 v44, v136, v137
    v_cvt_pk_bf16_f32 v45, v138, v139
    v_cvt_pk_bf16_f32 v46, v140, v141
    v_cvt_pk_bf16_f32 v47, v142, v143
    ds_write_b128 v248, v[44:47] offset:16384
    v_pk_fma_f32 v[144:145], v[144:145], v[104:105], v[96:97] op_sel_hi:[1,0,0]
    v_pk_fma_f32 v[146:147], v[146:147], v[104:105], v[96:97] op_sel_hi:[1,0,0]
    v_pk_fma_f32 v[148:149], v[148:149], v[104:105], v[96:97] op_sel_hi:[1,0,0]
    v_pk_fma_f32 v[150:151], v[150:151], v[104:105], v[96:97] op_sel_hi:[1,0,0]
    v_cvt_pk_bf16_f32 v48, v144, v145
    v_cvt_pk_bf16_f32 v49, v146, v147
    v_cvt_pk_bf16_f32 v50, v148, v149
    v_cvt_pk_bf16_f32 v51, v150, v151
    ds_write_b128 v248, v[48:51] offset:32768
    v_pk_fma_f32 v[152:153], v[152:153], v[104:105], v[96:97] op_sel_hi:[1,0,0]
    v_pk_fma_f32 v[154:155], v[154:155], v[104:105], v[96:97] op_sel_hi:[1,0,0]
    v_pk_fma_f32 v[156:157], v[156:157], v[104:105], v[96:97] op_sel_hi:[1,0,0]
    v_pk_fma_f32 v[158:159], v[158:159], v[104:105], v[96:97] op_sel_hi:[1,0,0]
    v_cvt_pk_bf16_f32 v52, v152, v153
    v_cvt_pk_bf16_f32 v53, v154, v155
    v_cvt_pk_bf16_f32 v54, v156, v157
    v_cvt_pk_bf16_f32 v55, v158, v159
    ds_write_b128 v248, v[52:55] offset:49152
    v_pk_fma_f32 v[160:161], v[160:161], v[104:105], v[96:97] op_sel_hi:[1,0,0]
    v_pk_fma_f32 v[162:163], v[162:163], v[104:105], v[96:97] op_sel_hi:[1,0,0]
    v_pk_fma_f32 v[164:165], v[164:165], v[104:105], v[96:97] op_sel_hi:[1,0,0]
    v_pk_fma_f32 v[166:167], v[166:167], v[104:105], v[96:97] op_sel_hi:[1,0,0]
    v_cvt_pk_bf16_f32 v56, v160, v161
    v_cvt_pk_bf16_f32 v57, v162, v163
    v_cvt_pk_bf16_f32 v58, v164, v165
    v_cvt_pk_bf16_f32 v59, v166, v167
    v_add_u32 v248, 0x10000, v248
    ds_write_b128 v248, v[56:59] offset:0
    s_cmp_eq_u32 s30, 3
    s_cbranch_scc0 parallel_sum__softmax_full_mha__swiglu_ffn__prompt_kernel_a_wd3
    s_mul_i32 s58, s2, 6272
    v_min_u32 v18, 48, v20
    v_lshlrev_b32 v18, 7, v18
    v_min_u32 v18, 6268, v18
    v_add_u32 v18, s58, v18
    s_mov_b32 exec_lo, 4294967295
    s_mov_b32 exec_hi, 131071
    global_load_dword v252, v18, s[28:29]
    s_mov_b64 exec, -1
parallel_sum__softmax_full_mha__swiglu_ffn__prompt_kernel_a_wd3:
    s_cmp_eq_u32 s30, 4
    s_cbranch_scc0 parallel_sum__softmax_full_mha__swiglu_ffn__prompt_kernel_a_wd4
    s_mul_i32 s58, s2, 1568
    v_min_u32 v18, 12, v20
    v_lshlrev_b32 v18, 7, v18
    v_min_u32 v18, 1564, v18
    v_add_u32 v18, s58, v18
    s_mov_b32 exec_lo, 8191
    s_mov_b32 exec_hi, 0
    s_waitcnt lgkmcnt(0)
    global_load_dword v253, v18, s[4:5]
    s_mov_b64 exec, -1
parallel_sum__softmax_full_mha__swiglu_ffn__prompt_kernel_a_wd4:
    v_lshlrev_b32 v18, 7, v20
    s_cmp_eq_u32 s30, 5
    s_cbranch_scc0 parallel_sum__softmax_full_mha__swiglu_ffn__prompt_kernel_a_wu1
    s_mul_i32 s58, s2, 6272
    s_mov_b32 exec_hi, 0x0000ffff
    s_waitcnt vmcnt(0)
    buffer_load_dword v253, v18, s[12:15], s58 offen
    s_mov_b64 exec, -1
parallel_sum__softmax_full_mha__swiglu_ffn__prompt_kernel_a_wu1:
    s_cmp_eq_u32 s30, 6
    s_cbranch_scc0 parallel_sum__softmax_full_mha__swiglu_ffn__prompt_kernel_a_wu2
    s_mul_i32 s58, s2, 6272
    s_mov_b32 exec_hi, 0x0000ffff
    buffer_load_dword v254, v18, s[16:19], s58 offen
    s_mov_b64 exec, -1
parallel_sum__softmax_full_mha__swiglu_ffn__prompt_kernel_a_wu2:
    v_pk_fma_f32 v[168:169], v[168:169], v[104:105], v[96:97] op_sel_hi:[1,0,0]
    v_pk_fma_f32 v[170:171], v[170:171], v[104:105], v[96:97] op_sel_hi:[1,0,0]
    v_pk_fma_f32 v[172:173], v[172:173], v[104:105], v[96:97] op_sel_hi:[1,0,0]
    v_pk_fma_f32 v[174:175], v[174:175], v[104:105], v[96:97] op_sel_hi:[1,0,0]
    v_cvt_pk_bf16_f32 v60, v168, v169
    v_cvt_pk_bf16_f32 v61, v170, v171
    v_cvt_pk_bf16_f32 v62, v172, v173
    v_cvt_pk_bf16_f32 v63, v174, v175
    ds_write_b128 v248, v[60:63] offset:16384
    v_pk_fma_f32 v[176:177], v[176:177], v[104:105], v[96:97] op_sel_hi:[1,0,0]
    v_pk_fma_f32 v[178:179], v[178:179], v[104:105], v[96:97] op_sel_hi:[1,0,0]
    v_pk_fma_f32 v[180:181], v[180:181], v[104:105], v[96:97] op_sel_hi:[1,0,0]
    v_pk_fma_f32 v[182:183], v[182:183], v[104:105], v[96:97] op_sel_hi:[1,0,0]
    v_cvt_pk_bf16_f32 v64, v176, v177
    v_cvt_pk_bf16_f32 v65, v178, v179
    v_cvt_pk_bf16_f32 v66, v180, v181
    v_cvt_pk_bf16_f32 v67, v182, v183
    ds_write_b128 v248, v[64:67] offset:32768
    s_cmp_eq_u32 s37, 0
    s_cbranch_scc1 parallel_sum__softmax_full_mha__swiglu_ffn__prompt_kernel_a_seqA
    s_waitcnt vmcnt(4) lgkmcnt(0)
    s_barrier
    ds_read_b128 v[128:131], v240 offset:0
    ds_read_b64_tr_b16 v[40:41], v4 offset:0
    ds_read_b64_tr_b16 v[42:43], v4 offset:512
    ds_read_b128 v[132:135], v241 offset:0
    ds_read_b64_tr_b16 v[44:45], v4 offset:2048
    ds_read_b64_tr_b16 v[46:47], v4 offset:2560
    ds_read_b128 v[136:139], v242 offset:0
    ds_read_b64_tr_b16 v[48:49], v4 offset:4096
    ds_read_b64_tr_b16 v[50:51], v4 offset:4608
    ds_read_b128 v[140:143], v243 offset:0
    ds_read_b128 v[144:147], v240 offset:16384
    ds_read_b128 v[148:151], v241 offset:16384
    ds_read_b128 v[152:155], v242 offset:16384
    ds_read_b128 v[156:159], v243 offset:16384
    ds_read_b128 v[160:163], v240 offset:32768
    ds_read_b128 v[164:167], v241 offset:32768
    ds_read_b64_tr_b16 v[52:53], v4 offset:6144
    ds_read_b64_tr_b16 v[54:55], v4 offset:6656
    s_waitcnt lgkmcnt(15)
    v_mfma_f32_32x32x16_bf16 v[56:71], v[128:131], v[40:43], 0
    s_waitcnt vmcnt(2) lgkmcnt(8)
    s_barrier
    s_add_u32 m0, s49, 0
    s_add_u32 s61, s50, 0
    buffer_load_dwordx4 v8, s[8:11], s47 offen lds
    s_mov_b32 m0, s61
    s_add_u32 s47, s47, 301056
    buffer_load_dwordx4 v8, s[8:11], s48 offen lds
    s_add_u32 s48, s48, 301056
    ds_read_b128 v[168:171], v242 offset:32768
    ds_read_b128 v[172:175], v243 offset:32768
    ds_read_b128 v[176:179], v240 offset:49152
    ds_read_b128 v[180:183], v241 offset:49152
    ds_read_b64_tr_b16 v[40:41], v4 offset:8192
    ds_read_b64_tr_b16 v[42:43], v4 offset:8704
    v_mfma_f32_32x32x16_bf16 v[56:71], v[132:135], v[44:47], v[56:71]
    ds_read_b128 v[184:187], v242 offset:49152
    ds_read_b128 v[188:191], v243 offset:49152
    v_add_u32 v240, 0x10000, v240
    v_add_u32 v241, 0x10000, v241
    v_add_u32 v242, 0x10000, v242
    v_add_u32 v243, 0x10000, v243
    ds_read_b128 v[192:195], v240 offset:0
    ds_read_b128 v[196:199], v241 offset:0
    ds_read_b64_tr_b16 v[44:45], v4 offset:10240
    ds_read_b64_tr_b16 v[46:47], v4 offset:10752
    v_mfma_f32_32x32x16_bf16 v[56:71], v[136:139], v[48:51], v[56:71]
    ds_read_b128 v[200:203], v242 offset:0
    ds_read_b128 v[204:207], v243 offset:0
    ds_read_b128 v[208:211], v240 offset:16384
    ds_read_b128 v[212:215], v241 offset:16384
    ds_read_b64_tr_b16 v[48:49], v4 offset:12288
    ds_read_b64_tr_b16 v[50:51], v4 offset:12800
    s_waitcnt lgkmcnt(15)
    v_mfma_f32_32x32x16_bf16 v[56:71], v[140:143], v[52:55], v[56:71]
    ds_read_b128 v[216:219], v242 offset:16384
    ds_read_b128 v[220:223], v243 offset:16384
    ds_read_b128 v[224:227], v240 offset:32768
    ds_read_b128 v[228:231], v241 offset:32768
    ds_read_b64_tr_b16 v[52:53], v4 offset:14336
    ds_read_b64_tr_b16 v[54:55], v4 offset:14848
    s_waitcnt lgkmcnt(15)
    v_mfma_f32_32x32x16_bf16 v[56:71], v[144:147], v[40:43], v[56:71]
    ds_read_b128 v[232:235], v242 offset:32768
    ds_read_b128 v[236:239], v243 offset:32768
    ds_read_b64_tr_b16 v[40:41], v4 offset:16384
    ds_read_b64_tr_b16 v[42:43], v4 offset:16896
    s_waitcnt lgkmcnt(15)
    v_mfma_f32_32x32x16_bf16 v[56:71], v[148:151], v[44:47], v[56:71]
    s_waitcnt lgkmcnt(2)
    s_barrier
    s_add_u32 s47, s41, s46
    s_add_u32 s48, s47, s52
    s_add_u32 m0, s49, 14336
    s_add_u32 s61, s50, 14336
    buffer_load_dwordx4 v9, s[12:15], s47 offen lds
    s_mov_b32 m0, s61
    s_add_u32 s47, s47, 401408
    buffer_load_dwordx4 v9, s[12:15], s48 offen lds
    s_add_u32 s48, s48, 401408
    ds_read_b64_tr_b16 v[44:45], v4 offset:18432
    ds_read_b64_tr_b16 v[46:47], v4 offset:18944
    v_mfma_f32_32x32x16_bf16 v[56:71], v[152:155], v[48:51], v[56:71]
    ds_read_b64_tr_b16 v[48:49], v4 offset:20480
    ds_read_b64_tr_b16 v[50:51], v4 offset:20992
    v_mfma_f32_32x32x16_bf16 v[56:71], v[156:159], v[52:55], v[56:71]
    ds_read_b64_tr_b16 v[52:53], v4 offset:22528
    ds_read_b64_tr_b16 v[54:55], v4 offset:23040
    s_waitcnt lgkmcnt(6)
    v_mfma_f32_32x32x16_bf16 v[56:71], v[160:163], v[40:43], v[56:71]
    ds_read_b64_tr_b16 v[40:41], v4 offset:24576
    ds_read_b64_tr_b16 v[42:43], v4 offset:25088
    s_waitcnt lgkmcnt(6)
    v_mfma_f32_32x32x16_bf16 v[56:71], v[164:167], v[44:47], v[56:71]
    s_add_u32 m0, s49, 28672
    s_add_u32 s61, s50, 28672
    buffer_load_dwordx4 v9, s[12:15], s47 offen lds
    s_mov_b32 m0, s61
    s_add_u32 s47, s47, 401408
    buffer_load_dwordx4 v9, s[12:15], s48 offen lds
    s_add_u32 s48, s48, 401408
    ds_read_b64_tr_b16 v[44:45], v4 offset:26624
    ds_read_b64_tr_b16 v[46:47], v4 offset:27136
    s_waitcnt lgkmcnt(6)
    v_mfma_f32_32x32x16_bf16 v[56:71], v[168:171], v[48:51], v[56:71]
    s_waitcnt vmcnt(6)
    s_barrier
    ds_read_b64_tr_b16 v[48:49], v4 offset:28672
    ds_read_b64_tr_b16 v[50:51], v4 offset:29184
    s_waitcnt lgkmcnt(6)
    v_mfma_f32_32x32x16_bf16 v[56:71], v[172:175], v[52:55], v[56:71]
    ds_read_b64_tr_b16 v[52:53], v4 offset:30720
    ds_read_b64_tr_b16 v[54:55], v4 offset:31232
    s_waitcnt lgkmcnt(6)
    v_mfma_f32_32x32x16_bf16 v[56:71], v[176:179], v[40:43], v[56:71]
    ds_read_b64_tr_b16 v[40:41], v4 offset:32768
    ds_read_b64_tr_b16 v[42:43], v4 offset:33280
    s_waitcnt lgkmcnt(6)
    v_mfma_f32_32x32x16_bf16 v[56:71], v[180:183], v[44:47], v[56:71]
    s_add_u32 m0, s49, 43008
    s_add_u32 s61, s50, 43008
    buffer_load_dwordx4 v9, s[12:15], s47 offen lds
    s_mov_b32 m0, s61
    s_add_u32 s47, s47, 401408
    buffer_load_dwordx4 v9, s[12:15], s48 offen lds
    s_add_u32 s48, s48, 401408
    ds_read_b64_tr_b16 v[44:45], v4 offset:34816
    ds_read_b64_tr_b16 v[46:47], v4 offset:35328
    s_waitcnt lgkmcnt(6)
    v_mfma_f32_32x32x16_bf16 v[56:71], v[184:187], v[48:51], v[56:71]
    ds_read_b64_tr_b16 v[48:49], v4 offset:36864
    ds_read_b64_tr_b16 v[50:51], v4 offset:37376
    s_waitcnt lgkmcnt(6)
    v_mfma_f32_32x32x16_bf16 v[56:71], v[188:191], v[52:55], v[56:71]
    ds_read_b64_tr_b16 v[52:53], v4 offset:38912
    ds_read_b64_tr_b16 v[54:55], v4 offset:39424
    s_waitcnt lgkmcnt(6)
    v_mfma_f32_32x32x16_bf16 v[56:71], v[192:195], v[40:43], v[56:71]
    ds_read_b64_tr_b16 v[40:41], v4 offset:40960
    ds_read_b64_tr_b16 v[42:43], v4 offset:41472
    s_waitcnt lgkmcnt(6)
    v_mfma_f32_32x32x16_bf16 v[56:71], v[196:199], v[44:47], v[56:71]
    s_waitcnt vmcnt(6)
    s_barrier
    ds_read_b64_tr_b16 v[44:45], v2 offset:0
    ds_read_b64_tr_b16 v[46:47], v2 offset:512
    s_waitcnt lgkmcnt(6)
    v_mfma_f32_32x32x16_bf16 v[56:71], v[200:203], v[48:51], v[56:71]
    s_add_u32 m0, s49, 57344
    s_add_u32 s61, s50, 57344
    buffer_load_dwordx4 v9, s[12:15], s47 offen lds
    s_mov_b32 m0, s61
    s_add_u32 s47, s47, 401408
    buffer_load_dwordx4 v9, s[12:15], s48 offen lds
    s_add_u32 s48, s48, 401408
    ds_read_b64_tr_b16 v[48:49], v2 offset:2048
    ds_read_b64_tr_b16 v[50:51], v2 offset:2560
    s_waitcnt lgkmcnt(6)
    v_mfma_f32_32x32x16_bf16 v[56:71], v[204:207], v[52:55], v[56:71]
    ds_read_b64_tr_b16 v[52:53], v2 offset:4096
    ds_read_b64_tr_b16 v[54:55], v2 offset:4608
    s_waitcnt lgkmcnt(6)
    v_mfma_f32_32x32x16_bf16 v[56:71], v[208:211], v[40:43], v[56:71]
    ds_read_b64_tr_b16 v[40:41], v2 offset:6144
    ds_read_b64_tr_b16 v[42:43], v2 offset:6656
    s_waitcnt lgkmcnt(6)
    v_mfma_f32_32x32x16_bf16 v[56:71], v[212:215], v[44:47], v[56:71]
    ds_read_b64_tr_b16 v[44:45], v2 offset:8192
    ds_read_b64_tr_b16 v[46:47], v2 offset:8704
    s_waitcnt lgkmcnt(6)
    v_mfma_f32_32x32x16_bf16 v[56:71], v[216:219], v[48:51], v[56:71]
    ds_read_b64_tr_b16 v[48:49], v2 offset:10240
    ds_read_b64_tr_b16 v[50:51], v2 offset:10752
    s_waitcnt lgkmcnt(6)
    v_mfma_f32_32x32x16_bf16 v[56:71], v[220:223], v[52:55], v[56:71]
    s_add_u32 s47, s42, s46
    s_add_u32 s48, s47, s52
    s_add_u32 m0, s49, 71680
    s_add_u32 s61, s50, 71680
    buffer_load_dwordx4 v9, s[16:19], s47 offen lds
    s_mov_b32 m0, s61
    s_add_u32 s47, s47, 401408
    buffer_load_dwordx4 v9, s[16:19], s48 offen lds
    s_add_u32 s48, s48, 401408
    ds_read_b64_tr_b16 v[52:53], v2 offset:12288
    ds_read_b64_tr_b16 v[54:55], v2 offset:12800
    s_waitcnt lgkmcnt(6)
    v_mfma_f32_32x32x16_bf16 v[56:71], v[224:227], v[40:43], v[56:71]
    s_waitcnt vmcnt(8)
    s_barrier
    ds_read_b64_tr_b16 v[40:41], v5 offset:14336
    ds_read_b64_tr_b16 v[42:43], v5 offset:14848
    s_waitcnt lgkmcnt(6)
    v_mfma_f32_32x32x16_bf16 v[56:71], v[228:231], v[44:47], v[56:71]
    ds_read_b64_tr_b16 v[44:45], v5 offset:16384
    ds_read_b64_tr_b16 v[46:47], v5 offset:16896
    s_waitcnt lgkmcnt(6)
    v_mfma_f32_32x32x16_bf16 v[56:71], v[232:235], v[48:51], v[56:71]
    ds_read_b64_tr_b16 v[48:49], v5 offset:18432
    ds_read_b64_tr_b16 v[50:51], v5 offset:18944
    s_waitcnt lgkmcnt(6)
    v_mfma_f32_32x32x16_bf16 v[88:103], v[236:239], v[52:55], v[56:71]
    ds_read_b64_tr_b16 v[52:53], v5 offset:20480
    ds_read_b64_tr_b16 v[54:55], v5 offset:20992
    s_waitcnt lgkmcnt(6)
    v_mfma_f32_32x32x16_bf16 v[56:71], v[40:43], v[128:131], 0
    ds_read_b64_tr_b16 v[40:41], v5 offset:22528
    ds_read_b64_tr_b16 v[42:43], v5 offset:23040
    s_waitcnt lgkmcnt(6)
    v_mfma_f32_32x32x16_bf16 v[56:71], v[44:47], v[132:135], v[56:71]
    s_add_u32 m0, s49, 86016
    s_add_u32 s61, s50, 86016
    buffer_load_dwordx4 v9, s[16:19], s47 offen lds
    s_mov_b32 m0, s61
    s_add_u32 s47, s47, 401408
    buffer_load_dwordx4 v9, s[16:19], s48 offen lds
    s_add_u32 s48, s48, 401408
    v_cvt_pk_bf16_f32 v120, v88, v89
    ds_read_b64_tr_b16 v[44:45], v5 offset:24576
    ds_read_b64_tr_b16 v[46:47], v5 offset:25088
    s_waitcnt lgkmcnt(6)
    v_mfma_f32_32x32x16_bf16 v[56:71], v[48:51], v[136:139], v[56:71]
    v_cvt_pk_bf16_f32 v121, v90, v91
    ds_read_b64_tr_b16 v[48:49], v5 offset:26624
    ds_read_b64_tr_b16 v[50:51], v5 offset:27136
    s_waitcnt lgkmcnt(6)
    v_mfma_f32_32x32x16_bf16 v[56:71], v[52:55], v[140:143], v[56:71]
    v_cvt_pk_bf16_f32 v122, v92, v93
    s_waitcnt vmcnt(8)
    s_barrier
    ds_read_b64_tr_b16 v[52:53], v5 offset:28672
    ds_read_b64_tr_b16 v[54:55], v5 offset:29184
    s_waitcnt lgkmcnt(6)
    v_mfma_f32_32x32x16_bf16 v[56:71], v[40:43], v[144:147], v[56:71]
    v_cvt_pk_bf16_f32 v123, v94, v95
    ds_read_b64_tr_b16 v[40:41], v5 offset:30720
    ds_read_b64_tr_b16 v[42:43], v5 offset:31232
    s_waitcnt lgkmcnt(6)
    v_mfma_f32_32x32x16_bf16 v[56:71], v[44:47], v[148:151], v[56:71]
    s_add_u32 m0, s49, 100352
    s_add_u32 s61, s50, 100352
    buffer_load_dwordx4 v9, s[16:19], s47 offen lds
    s_mov_b32 m0, s61
    s_add_u32 s47, s47, 401408
    buffer_load_dwordx4 v9, s[16:19], s48 offen lds
    s_add_u32 s48, s48, 401408
    v_cvt_pk_bf16_f32 v124, v96, v97
    v_cvt_pk_bf16_f32 v125, v98, v99
    ds_read_b64_tr_b16 v[44:45], v5 offset:32768
    ds_read_b64_tr_b16 v[46:47], v5 offset:33280
    s_waitcnt lgkmcnt(6)
    v_mfma_f32_32x32x16_bf16 v[56:71], v[48:51], v[152:155], v[56:71]
    v_cvt_pk_bf16_f32 v126, v100, v101
    ds_read_b64_tr_b16 v[48:49], v5 offset:34816
    ds_read_b64_tr_b16 v[50:51], v5 offset:35328
    s_waitcnt lgkmcnt(6)
    v_mfma_f32_32x32x16_bf16 v[56:71], v[52:55], v[156:159], v[56:71]
    v_cvt_pk_bf16_f32 v127, v102, v103
    ds_read_b64_tr_b16 v[52:53], v5 offset:36864
    ds_read_b64_tr_b16 v[54:55], v5 offset:37376
    s_waitcnt lgkmcnt(6)
    v_mfma_f32_32x32x16_bf16 v[56:71], v[40:43], v[160:163], v[56:71]
    v_cndmask_b32 v120, v120, v28, s[56:57]
    ds_read_b64_tr_b16 v[40:41], v5 offset:38912
    ds_read_b64_tr_b16 v[42:43], v5 offset:39424
    s_waitcnt lgkmcnt(6)
    v_mfma_f32_32x32x16_bf16 v[56:71], v[44:47], v[164:167], v[56:71]
    s_add_u32 m0, s49, 114688
    s_add_u32 s61, s50, 114688
    buffer_load_dwordx4 v9, s[16:19], s47 offen lds
    s_mov_b32 m0, s61
    s_add_u32 s47, s47, 401408
    buffer_load_dwordx4 v9, s[16:19], s48 offen lds
    s_add_u32 s48, s48, 401408
    v_cndmask_b32 v121, v121, v28, s[56:57]
    ds_read_b64_tr_b16 v[44:45], v5 offset:40960
    ds_read_b64_tr_b16 v[46:47], v5 offset:41472
    s_waitcnt lgkmcnt(6)
    v_mfma_f32_32x32x16_bf16 v[56:71], v[48:51], v[168:171], v[56:71]
    v_cndmask_b32 v122, v122, v28, s[56:57]
    v_cndmask_b32 v123, v123, v28, s[56:57]
    s_waitcnt vmcnt(10)
    s_barrier
    ds_read_b64_tr_b16 v[48:49], v5 offset:43008
    ds_read_b64_tr_b16 v[50:51], v5 offset:43520
    s_waitcnt lgkmcnt(6)
    v_mfma_f32_32x32x16_bf16 v[56:71], v[52:55], v[172:175], v[56:71]
    v_cndmask_b32 v124, v124, v28, s[56:57]
    ds_read_b64_tr_b16 v[52:53], v5 offset:45056
    ds_read_b64_tr_b16 v[54:55], v5 offset:45568
    s_waitcnt lgkmcnt(6)
    v_mfma_f32_32x32x16_bf16 v[56:71], v[40:43], v[176:179], v[56:71]
    v_cndmask_b32 v125, v125, v28, s[56:57]
    ds_read_b64_tr_b16 v[40:41], v5 offset:47104
    ds_read_b64_tr_b16 v[42:43], v5 offset:47616
    s_waitcnt lgkmcnt(6)
    v_mfma_f32_32x32x16_bf16 v[56:71], v[44:47], v[180:183], v[56:71]
    s_add_u32 s47, s43, s46
    s_add_u32 s48, s47, s52
    s_add_u32 m0, s49, 129024
    s_add_u32 s61, s50, 129024
    buffer_load_dwordx4 v9, s[12:15], s47 offen lds
    s_mov_b32 m0, s61
    s_add_u32 s47, s47, 401408
    buffer_load_dwordx4 v9, s[12:15], s48 offen lds
    s_add_u32 s48, s48, 401408
    v_cndmask_b32 v126, v126, v28, s[56:57]
    ds_read_b64_tr_b16 v[44:45], v5 offset:49152
    ds_read_b64_tr_b16 v[46:47], v5 offset:49664
    s_waitcnt lgkmcnt(6)
    v_mfma_f32_32x32x16_bf16 v[56:71], v[48:51], v[184:187], v[56:71]
    v_cndmask_b32 v127, v127, v28, s[56:57]
    ds_read_b64_tr_b16 v[48:49], v5 offset:51200
    ds_read_b64_tr_b16 v[50:51], v5 offset:51712
    s_waitcnt lgkmcnt(6)
    v_mfma_f32_32x32x16_bf16 v[56:71], v[52:55], v[188:191], v[56:71]
    buffer_store_dwordx4 v[120:123], v1, s[20:23], s64 offen sc1
    buffer_store_dwordx4 v[124:127], v1, s[20:23], s64 offen offset:1024 sc1
    ds_read_b64_tr_b16 v[52:53], v5 offset:53248
    ds_read_b64_tr_b16 v[54:55], v5 offset:53760
    s_waitcnt lgkmcnt(6)
    v_mfma_f32_32x32x16_bf16 v[56:71], v[40:43], v[192:195], v[56:71]
    ds_read_b64_tr_b16 v[40:41], v5 offset:55296
    ds_read_b64_tr_b16 v[42:43], v5 offset:55808
    s_waitcnt lgkmcnt(6)
    v_mfma_f32_32x32x16_bf16 v[56:71], v[44:47], v[196:199], v[56:71]
    s_add_u32 m0, s49, 143360
    s_add_u32 s61, s50, 143360
    buffer_load_dwordx4 v9, s[12:15], s47 offen lds
    s_mov_b32 m0, s61
    s_add_u32 s47, s47, 401408
    buffer_load_dwordx4 v9, s[12:15], s48 offen lds
    s_add_u32 s48, s48, 401408
    s_waitcnt vmcnt(12)
    s_barrier
    ds_read_b64_tr_b16 v[44:45], v6 offset:0
    ds_read_b64_tr_b16 v[46:47], v6 offset:512
    s_waitcnt lgkmcnt(6)
    v_mfma_f32_32x32x16_bf16 v[56:71], v[48:51], v[200:203], v[56:71]
    ds_read_b64_tr_b16 v[48:49], v6 offset:2048
    ds_read_b64_tr_b16 v[50:51], v6 offset:2560
    s_waitcnt lgkmcnt(6)
    v_mfma_f32_32x32x16_bf16 v[56:71], v[52:55], v[204:207], v[56:71]
    ds_read_b64_tr_b16 v[52:53], v6 offset:4096
    ds_read_b64_tr_b16 v[54:55], v6 offset:4608
    s_waitcnt lgkmcnt(6)
    v_mfma_f32_32x32x16_bf16 v[56:71], v[40:43], v[208:211], v[56:71]
    ds_read_b64_tr_b16 v[40:41], v6 offset:6144
    ds_read_b64_tr_b16 v[42:43], v6 offset:6656
    s_waitcnt lgkmcnt(6)
    v_mfma_f32_32x32x16_bf16 v[56:71], v[44:47], v[212:215], v[56:71]
    s_add_u32 m0, s49, 0
    s_add_u32 s61, s50, 0
    buffer_load_dwordx4 v9, s[12:15], s47 offen lds
    s_mov_b32 m0, s61
    s_add_u32 s47, s47, 401408
    buffer_load_dwordx4 v9, s[12:15], s48 offen lds
    s_add_u32 s48, s48, 401408
    ds_read_b64_tr_b16 v[44:45], v6 offset:8192
    ds_read_b64_tr_b16 v[46:47], v6 offset:8704
    s_waitcnt lgkmcnt(6)
    v_mfma_f32_32x32x16_bf16 v[56:71], v[48:51], v[216:219], v[56:71]
    ds_read_b64_tr_b16 v[48:49], v6 offset:10240
    ds_read_b64_tr_b16 v[50:51], v6 offset:10752
    s_waitcnt lgkmcnt(6)
    v_mfma_f32_32x32x16_bf16 v[56:71], v[52:55], v[220:223], v[56:71]
    ds_read_b64_tr_b16 v[52:53], v6 offset:12288
    ds_read_b64_tr_b16 v[54:55], v6 offset:12800
    s_waitcnt lgkmcnt(6)
    v_mfma_f32_32x32x16_bf16 v[56:71], v[40:43], v[224:227], v[56:71]
    ds_read_b64_tr_b16 v[40:41], v6 offset:14336
    ds_read_b64_tr_b16 v[42:43], v6 offset:14848
    s_waitcnt lgkmcnt(6)
    v_mfma_f32_32x32x16_bf16 v[56:71], v[44:47], v[228:231], v[56:71]
    ds_read_b64_tr_b16 v[44:45], v6 offset:16384
    ds_read_b64_tr_b16 v[46:47], v6 offset:16896
    s_waitcnt lgkmcnt(6)
    v_mfma_f32_32x32x16_bf16 v[56:71], v[48:51], v[232:235], v[56:71]
    ds_read_b64_tr_b16 v[48:49], v6 offset:18432
    ds_read_b64_tr_b16 v[50:51], v6 offset:18944
    s_waitcnt lgkmcnt(6)
    v_mfma_f32_32x32x16_bf16 v[72:87], v[52:55], v[236:239], v[56:71]
    s_waitcnt vmcnt(6)
    s_barrier
    ds_read_b64_tr_b16 v[52:53], v6 offset:20480
    ds_read_b64_tr_b16 v[54:55], v6 offset:20992
    s_waitcnt lgkmcnt(6)
    v_mfma_f32_32x32x16_bf16 v[56:71], v[40:43], v[128:131], 0
    s_add_u32 m0, s49, 14336
    s_add_u32 s61, s50, 14336
    buffer_load_dwordx4 v9, s[12:15], s47 offen lds
    s_mov_b32 m0, s61
    s_add_u32 s47, s47, 401408
    buffer_load_dwordx4 v9, s[12:15], s48 offen lds
    s_add_u32 s48, s48, 401408
    ds_read_b64_tr_b16 v[40:41], v6 offset:22528
    ds_read_b64_tr_b16 v[42:43], v6 offset:23040
    s_waitcnt lgkmcnt(6)
    v_mfma_f32_32x32x16_bf16 v[56:71], v[44:47], v[132:135], v[56:71]
    ds_read_b64_tr_b16 v[44:45], v6 offset:24576
    ds_read_b64_tr_b16 v[46:47], v6 offset:25088
    s_waitcnt lgkmcnt(6)
    v_mfma_f32_32x32x16_bf16 v[56:71], v[48:51], v[136:139], v[56:71]
    ds_read_b64_tr_b16 v[48:49], v6 offset:26624
    ds_read_b64_tr_b16 v[50:51], v6 offset:27136
    s_waitcnt lgkmcnt(6)
    v_mfma_f32_32x32x16_bf16 v[56:71], v[52:55], v[140:143], v[56:71]
    ds_read_b64_tr_b16 v[52:53], v6 offset:28672
    ds_read_b64_tr_b16 v[54:55], v6 offset:29184
    s_waitcnt lgkmcnt(6)
    v_mfma_f32_32x32x16_bf16 v[56:71], v[40:43], v[144:147], v[56:71]
    ds_read_b64_tr_b16 v[40:41], v6 offset:30720
    ds_read_b64_tr_b16 v[42:43], v6 offset:31232
    s_waitcnt lgkmcnt(6)
    v_mfma_f32_32x32x16_bf16 v[56:71], v[44:47], v[148:151], v[56:71]
    ds_read_b64_tr_b16 v[44:45], v6 offset:32768
    ds_read_b64_tr_b16 v[46:47], v6 offset:33280
    s_waitcnt lgkmcnt(6)
    v_mfma_f32_32x32x16_bf16 v[56:71], v[48:51], v[152:155], v[56:71]
    ds_read_b64_tr_b16 v[48:49], v6 offset:34816
    ds_read_b64_tr_b16 v[50:51], v6 offset:35328
    s_waitcnt lgkmcnt(6)
    v_mfma_f32_32x32x16_bf16 v[56:71], v[52:55], v[156:159], v[56:71]
    s_add_u32 s47, s44, s46
    s_add_u32 s48, s47, s52
    s_add_u32 m0, s49, 28672
    s_add_u32 s61, s50, 28672
    buffer_load_dwordx4 v9, s[16:19], s47 offen lds
    s_mov_b32 m0, s61
    s_add_u32 s47, s47, 401408
    buffer_load_dwordx4 v9, s[16:19], s48 offen lds
    s_add_u32 s48, s48, 401408
    ds_read_b64_tr_b16 v[52:53], v6 offset:36864
    ds_read_b64_tr_b16 v[54:55], v6 offset:37376
    s_waitcnt lgkmcnt(6)
    v_mfma_f32_32x32x16_bf16 v[56:71], v[40:43], v[160:163], v[56:71]
    ds_read_b64_tr_b16 v[40:41], v6 offset:38912
    ds_read_b64_tr_b16 v[42:43], v6 offset:39424
    s_waitcnt lgkmcnt(6)
    v_mfma_f32_32x32x16_bf16 v[56:71], v[44:47], v[164:167], v[56:71]
    ds_read_b64_tr_b16 v[44:45], v6 offset:40960
    ds_read_b64_tr_b16 v[46:47], v6 offset:41472
    s_waitcnt lgkmcnt(6)
    v_mfma_f32_32x32x16_bf16 v[56:71], v[48:51], v[168:171], v[56:71]
    s_waitcnt vmcnt(8)
    s_barrier
    s_cmp_eq_u32 s30, 0
    s_cbranch_scc0 parallel_sum__softmax_full_mha__swiglu_ffn__prompt_kernel_fs1
    s_lshl_b32 s58, s75, 2
    s_add_u32 s58, s58, 16782336
    v_mov_b32 v26, s3
    v_mov_b32 v27, 0
    buffer_store_dword v26, v27, s[20:23], s58 offen sc1
parallel_sum__softmax_full_mha__swiglu_ffn__prompt_kernel_fs1:
    ds_read_b64_tr_b16 v[48:49], v6 offset:43008
    ds_read_b64_tr_b16 v[50:51], v6 offset:43520
    s_waitcnt lgkmcnt(6)
    v_mfma_f32_32x32x16_bf16 v[56:71], v[52:55], v[172:175], v[56:71]
    ds_read_b64_tr_b16 v[52:53], v6 offset:45056
    ds_read_b64_tr_b16 v[54:55], v6 offset:45568
    s_waitcnt lgkmcnt(6)
    v_mfma_f32_32x32x16_bf16 v[56:71], v[40:43], v[176:179], v[56:71]
    ds_read_b64_tr_b16 v[40:41], v6 offset:47104
    ds_read_b64_tr_b16 v[42:43], v6 offset:47616
    s_waitcnt lgkmcnt(6)
    v_mfma_f32_32x32x16_bf16 v[56:71], v[44:47], v[180:183], v[56:71]
    ds_read_b64_tr_b16 v[44:45], v6 offset:49152
    ds_read_b64_tr_b16 v[46:47], v6 offset:49664
    s_waitcnt lgkmcnt(6)
    v_mfma_f32_32x32x16_bf16 v[56:71], v[48:51], v[184:187], v[56:71]
    s_add_u32 m0, s49, 43008
    s_add_u32 s61, s50, 43008
    buffer_load_dwordx4 v9, s[16:19], s47 offen lds
    s_mov_b32 m0, s61
    s_add_u32 s47, s47, 401408
    buffer_load_dwordx4 v9, s[16:19], s48 offen lds
    s_add_u32 s48, s48, 401408
    ds_read_b64_tr_b16 v[48:49], v6 offset:51200
    ds_read_b64_tr_b16 v[50:51], v6 offset:51712
    s_waitcnt lgkmcnt(6)
    v_mfma_f32_32x32x16_bf16 v[56:71], v[52:55], v[188:191], v[56:71]
    ds_read_b64_tr_b16 v[52:53], v6 offset:53248
    ds_read_b64_tr_b16 v[54:55], v6 offset:53760
    s_waitcnt lgkmcnt(6)
    v_mfma_f32_32x32x16_bf16 v[56:71], v[40:43], v[192:195], v[56:71]
    ds_read_b64_tr_b16 v[40:41], v6 offset:55296
    ds_read_b64_tr_b16 v[42:43], v6 offset:55808
    s_waitcnt lgkmcnt(6)
    v_mfma_f32_32x32x16_bf16 v[56:71], v[44:47], v[196:199], v[56:71]
    ds_read_b64_tr_b16 v[44:45], v7 offset:0
    ds_read_b64_tr_b16 v[46:47], v7 offset:512
    s_waitcnt lgkmcnt(6)
    v_mfma_f32_32x32x16_bf16 v[56:71], v[48:51], v[200:203], v[56:71]
    ds_read_b64_tr_b16 v[48:49], v7 offset:2048
    ds_read_b64_tr_b16 v[50:51], v7 offset:2560
    s_waitcnt lgkmcnt(6)
    v_mfma_f32_32x32x16_bf16 v[56:71], v[52:55], v[204:207], v[56:71]
    ds_read_b64_tr_b16 v[52:53], v7 offset:4096
    ds_read_b64_tr_b16 v[54:55], v7 offset:4608
    s_waitcnt lgkmcnt(6)
    v_mfma_f32_32x32x16_bf16 v[56:71], v[40:43], v[208:211], v[56:71]
    ds_read_b64_tr_b16 v[40:41], v7 offset:6144
    ds_read_b64_tr_b16 v[42:43], v7 offset:6656
    s_waitcnt lgkmcnt(6)
    v_mfma_f32_32x32x16_bf16 v[56:71], v[44:47], v[212:215], v[56:71]
    s_add_u32 m0, s49, 57344
    s_add_u32 s61, s50, 57344
    buffer_load_dwordx4 v9, s[16:19], s47 offen lds
    s_mov_b32 m0, s61
    s_add_u32 s47, s47, 401408
    buffer_load_dwordx4 v9, s[16:19], s48 offen lds
    s_add_u32 s48, s48, 401408
    ds_read_b64_tr_b16 v[44:45], v7 offset:8192
    ds_read_b64_tr_b16 v[46:47], v7 offset:8704
    s_waitcnt lgkmcnt(6)
    v_mfma_f32_32x32x16_bf16 v[56:71], v[48:51], v[216:219], v[56:71]
    ds_read_b64_tr_b16 v[48:49], v7 offset:10240
    ds_read_b64_tr_b16 v[50:51], v7 offset:10752
    s_waitcnt lgkmcnt(6)
    v_mfma_f32_32x32x16_bf16 v[56:71], v[52:55], v[220:223], v[56:71]
    ds_read_b64_tr_b16 v[52:53], v7 offset:12288
    ds_read_b64_tr_b16 v[54:55], v7 offset:12800
    s_waitcnt lgkmcnt(6)
    v_mfma_f32_32x32x16_bf16 v[56:71], v[40:43], v[224:227], v[56:71]
    ds_read_b64_tr_b16 v[40:41], v7 offset:14336
    ds_read_b64_tr_b16 v[42:43], v7 offset:14848
    s_waitcnt lgkmcnt(6)
    v_mfma_f32_32x32x16_bf16 v[56:71], v[44:47], v[228:231], v[56:71]
    ds_read_b64_tr_b16 v[44:45], v7 offset:16384
    ds_read_b64_tr_b16 v[46:47], v7 offset:16896
    s_waitcnt lgkmcnt(6)
    v_mfma_f32_32x32x16_bf16 v[56:71], v[48:51], v[232:235], v[56:71]
    ds_read_b64_tr_b16 v[48:49], v7 offset:18432
    ds_read_b64_tr_b16 v[50:51], v7 offset:18944
    s_waitcnt lgkmcnt(6)
    v_mfma_f32_32x32x16_bf16 v[88:103], v[52:55], v[236:239], v[56:71]
    s_waitcnt vmcnt(4)
    s_barrier
    ds_read_b64_tr_b16 v[52:53], v7 offset:20480
    ds_read_b64_tr_b16 v[54:55], v7 offset:20992
    s_waitcnt lgkmcnt(6)
    v_mfma_f32_32x32x16_bf16 v[56:71], v[40:43], v[128:131], 0
    s_add_u32 m0, s49, 71680
    s_add_u32 s61, s50, 71680
    buffer_load_dwordx4 v9, s[16:19], s47 offen lds
    s_mov_b32 m0, s61
    s_add_u32 s47, s47, 401408
    buffer_load_dwordx4 v9, s[16:19], s48 offen lds
    s_add_u32 s48, s48, 401408
    ds_read_b64_tr_b16 v[40:41], v7 offset:22528
    ds_read_b64_tr_b16 v[42:43], v7 offset:23040
    s_waitcnt lgkmcnt(6)
    v_mfma_f32_32x32x16_bf16 v[56:71], v[44:47], v[132:135], v[56:71]
    v_mul_f32 v104, 0xbfb8aa3b, v72
    v_mul_f32 v105, 0xbfb8aa3b, v73
    v_mul_f32 v106, 0xbfb8aa3b, v74
    v_mul_f32 v107, 0xbfb8aa3b, v75
    ds_read_b64_tr_b16 v[44:45], v7 offset:24576
    ds_read_b64_tr_b16 v[46:47], v7 offset:25088
    s_waitcnt lgkmcnt(6)
    v_mfma_f32_32x32x16_bf16 v[56:71], v[48:51], v[136:139], v[56:71]
    v_exp_f32 v104, v104
    v_mul_f32 v108, v72, v88
    v_exp_f32 v105, v105
    v_mul_f32 v109, v73, v89
    ds_read_b64_tr_b16 v[48:49], v7 offset:26624
    ds_read_b64_tr_b16 v[50:51], v7 offset:27136
    s_waitcnt lgkmcnt(6)
    v_mfma_f32_32x32x16_bf16 v[56:71], v[52:55], v[140:143], v[56:71]
    v_exp_f32 v106, v106
    v_mul_f32 v110, v74, v90
    v_exp_f32 v107, v107
    v_mul_f32 v111, v75, v91
    ds_read_b64_tr_b16 v[52:53], v7 offset:28672
    ds_read_b64_tr_b16 v[54:55], v7 offset:29184
    s_waitcnt lgkmcnt(6)
    v_mfma_f32_32x32x16_bf16 v[56:71], v[40:43], v[144:147], v[56:71]
    v_add_f32 v104, 1.0, v104
    v_add_f32 v105, 1.0, v105
    v_add_f32 v106, 1.0, v106
    v_add_f32 v107, 1.0, v107
    v_rcp_f32 v104, v104
    ds_read_b64_tr_b16 v[40:41], v7 offset:30720
    ds_read_b64_tr_b16 v[42:43], v7 offset:31232
    s_waitcnt lgkmcnt(6)
    v_mfma_f32_32x32x16_bf16 v[56:71], v[44:47], v[148:151], v[56:71]
    v_rcp_f32 v105, v105
    v_rcp_f32 v106, v106
    v_rcp_f32 v107, v107
    v_mul_f32 v108, v108, v104
    ds_read_b64_tr_b16 v[44:45], v7 offset:32768
    ds_read_b64_tr_b16 v[46:47], v7 offset:33280
    s_waitcnt lgkmcnt(6)
    v_mfma_f32_32x32x16_bf16 v[56:71], v[48:51], v[152:155], v[56:71]
    v_mul_f32 v109, v109, v105
    v_mul_f32 v110, v110, v106
    v_mul_f32 v111, v111, v107
    v_cvt_pk_bf16_f32 v112, v108, v109
    ds_read_b64_tr_b16 v[48:49], v7 offset:34816
    ds_read_b64_tr_b16 v[50:51], v7 offset:35328
    s_waitcnt lgkmcnt(6)
    v_mfma_f32_32x32x16_bf16 v[56:71], v[52:55], v[156:159], v[56:71]
    v_cvt_pk_bf16_f32 v113, v110, v111
    v_mul_f32 v104, 0xbfb8aa3b, v76
    v_mul_f32 v105, 0xbfb8aa3b, v77
    v_mul_f32 v106, 0xbfb8aa3b, v78
    ds_read_b64_tr_b16 v[52:53], v7 offset:36864
    ds_read_b64_tr_b16 v[54:55], v7 offset:37376
    s_waitcnt lgkmcnt(6)
    v_mfma_f32_32x32x16_bf16 v[56:71], v[40:43], v[160:163], v[56:71]
    v_mul_f32 v107, 0xbfb8aa3b, v79
    v_exp_f32 v104, v104
    v_mul_f32 v108, v76, v92
    v_exp_f32 v105, v105
    v_mul_f32 v109, v77, v93
    ds_read_b64_tr_b16 v[40:41], v7 offset:38912
    ds_read_b64_tr_b16 v[42:43], v7 offset:39424
    s_waitcnt lgkmcnt(6)
    v_mfma_f32_32x32x16_bf16 v[56:71], v[44:47], v[164:167], v[56:71]
    v_exp_f32 v106, v106
    v_mul_f32 v110, v78, v94
    v_exp_f32 v107, v107
    v_mul_f32 v111, v79, v95
    ds_read_b64_tr_b16 v[44:45], v7 offset:40960
    ds_read_b64_tr_b16 v[46:47], v7 offset:41472
    s_waitcnt lgkmcnt(6)
    v_mfma_f32_32x32x16_bf16 v[56:71], v[48:51], v[168:171], v[56:71]
    v_add_f32 v104, 1.0, v104
    v_add_f32 v105, 1.0, v105
    v_add_f32 v106, 1.0, v106
    v_add_f32 v107, 1.0, v107
    ds_read_b64_tr_b16 v[48:49], v5 offset:0
    ds_read_b64_tr_b16 v[50:51], v5 offset:512
    s_waitcnt lgkmcnt(6)
    v_mfma_f32_32x32x16_bf16 v[56:71], v[52:55], v[172:175], v[56:71]
    v_rcp_f32 v104, v104
    v_rcp_f32 v105, v105
    v_rcp_f32 v106, v106
    v_rcp_f32 v107, v107
    v_mul_f32 v108, v108, v104
    ds_read_b64_tr_b16 v[52:53], v5 offset:2048
    ds_read_b64_tr_b16 v[54:55], v5 offset:2560
    s_waitcnt lgkmcnt(6)
    v_mfma_f32_32x32x16_bf16 v[56:71], v[40:43], v[176:179], v[56:71]
    v_mul_f32 v109, v109, v105
    v_mul_f32 v110, v110, v106
    v_mul_f32 v111, v111, v107
    v_cvt_pk_bf16_f32 v114, v108, v109
    ds_read_b64_tr_b16 v[40:41], v5 offset:4096
    ds_read_b64_tr_b16 v[42:43], v5 offset:4608
    s_waitcnt lgkmcnt(6)
    v_mfma_f32_32x32x16_bf16 v[56:71], v[44:47], v[180:183], v[56:71]
    v_cvt_pk_bf16_f32 v115, v110, v111
    buffer_store_dwordx4 v[112:115], v1, s[20:23], s65 offen offset:0 sc1
    v_mul_f32 v104, 0xbfb8aa3b, v80
    v_mul_f32 v105, 0xbfb8aa3b, v81
    ds_read_b64_tr_b16 v[44:45], v5 offset:6144
    ds_read_b64_tr_b16 v[46:47], v5 offset:6656
    s_waitcnt lgkmcnt(6)
    v_mfma_f32_32x32x16_bf16 v[56:71], v[48:51], v[184:187], v[56:71]
    v_mul_f32 v106, 0xbfb8aa3b, v82
    v_mul_f32 v107, 0xbfb8aa3b, v83
    v_exp_f32 v104, v104
    v_mul_f32 v108, v80, v96
    ds_read_b64_tr_b16 v[48:49], v5 offset:8192
    ds_read_b64_tr_b16 v[50:51], v5 offset:8704
    s_waitcnt lgkmcnt(6)
    v_mfma_f32_32x32x16_bf16 v[56:71], v[52:55], v[188:191], v[56:71]
    v_exp_f32 v105, v105
    v_mul_f32 v109, v81, v97
    v_exp_f32 v106, v106
    v_mul_f32 v110, v82, v98
    v_exp_f32 v107, v107
    ds_read_b64_tr_b16 v[52:53], v5 offset:10240
    ds_read_b64_tr_b16 v[54:55], v5 offset:10752
    s_waitcnt lgkmcnt(6)
    v_mfma_f32_32x32x16_bf16 v[56:71], v[40:43], v[192:195], v[56:71]
    v_mul_f32 v111, v83, v99
    v_add_f32 v104, 1.0, v104
    v_add_f32 v105, 1.0, v105
    v_add_f32 v106, 1.0, v106
    ds_read_b64_tr_b16 v[40:41], v5 offset:12288
    ds_read_b64_tr_b16 v[42:43], v5 offset:12800
    s_waitcnt lgkmcnt(6)
    v_mfma_f32_32x32x16_bf16 v[56:71], v[44:47], v[196:199], v[56:71]
    v_add_f32 v107, 1.0, v107
    v_rcp_f32 v104, v104
    v_rcp_f32 v105, v105
    v_rcp_f32 v106, v106
    ds_read_b64_tr_b16 v[44:45], v5 offset:14336
    ds_read_b64_tr_b16 v[46:47], v5 offset:14848
    s_waitcnt lgkmcnt(6)
    v_mfma_f32_32x32x16_bf16 v[56:71], v[48:51], v[200:203], v[56:71]
    v_rcp_f32 v107, v107
    v_mul_f32 v108, v108, v104
    v_mul_f32 v109, v109, v105
    v_mul_f32 v110, v110, v106
    v_mul_f32 v111, v111, v107
    ds_read_b64_tr_b16 v[48:49], v5 offset:16384
    ds_read_b64_tr_b16 v[50:51], v5 offset:16896
    s_waitcnt lgkmcnt(6)
    v_mfma_f32_32x32x16_bf16 v[56:71], v[52:55], v[204:207], v[56:71]
    v_cvt_pk_bf16_f32 v116, v108, v109
    v_cvt_pk_bf16_f32 v117, v110, v111
    v_mul_f32 v104, 0xbfb8aa3b, v84
    v_mul_f32 v105, 0xbfb8aa3b, v85
    ds_read_b64_tr_b16 v[52:53], v5 offset:18432
    ds_read_b64_tr_b16 v[54:55], v5 offset:18944
    s_waitcnt lgkmcnt(6)
    v_mfma_f32_32x32x16_bf16 v[56:71], v[40:43], v[208:211], v[56:71]
    v_mul_f32 v106, 0xbfb8aa3b, v86
    v_mul_f32 v107, 0xbfb8aa3b, v87
    v_exp_f32 v104, v104
    v_mul_f32 v108, v84, v100
    ds_read_b64_tr_b16 v[40:41], v5 offset:20480
    ds_read_b64_tr_b16 v[42:43], v5 offset:20992
    s_waitcnt lgkmcnt(6)
    v_mfma_f32_32x32x16_bf16 v[56:71], v[44:47], v[212:215], v[56:71]
    v_exp_f32 v105, v105
    v_mul_f32 v109, v85, v101
    v_exp_f32 v106, v106
    v_mul_f32 v110, v86, v102
    ds_read_b64_tr_b16 v[44:45], v5 offset:22528
    ds_read_b64_tr_b16 v[46:47], v5 offset:23040
    s_waitcnt lgkmcnt(6)
    v_mfma_f32_32x32x16_bf16 v[56:71], v[48:51], v[216:219], v[56:71]
    v_exp_f32 v107, v107
    v_mul_f32 v111, v87, v103
    v_add_f32 v104, 1.0, v104
    v_add_f32 v105, 1.0, v105
    v_add_f32 v106, 1.0, v106
    ds_read_b64_tr_b16 v[48:49], v5 offset:24576
    ds_read_b64_tr_b16 v[50:51], v5 offset:25088
    s_waitcnt lgkmcnt(6)
    v_mfma_f32_32x32x16_bf16 v[56:71], v[52:55], v[220:223], v[56:71]
    v_add_f32 v107, 1.0, v107
    v_rcp_f32 v104, v104
    v_rcp_f32 v105, v105
    v_rcp_f32 v106, v106
    ds_read_b64_tr_b16 v[52:53], v5 offset:26624
    ds_read_b64_tr_b16 v[54:55], v5 offset:27136
    s_waitcnt lgkmcnt(6)
    v_mfma_f32_32x32x16_bf16 v[56:71], v[40:43], v[224:227], v[56:71]
    v_rcp_f32 v107, v107
    v_mul_f32 v108, v108, v104
    v_mul_f32 v109, v109, v105
    v_mul_f32 v110, v110, v106
    ds_read_b64_tr_b16 v[40:41], v5 offset:28672
    ds_read_b64_tr_b16 v[42:43], v5 offset:29184
    s_waitcnt lgkmcnt(6)
    v_mfma_f32_32x32x16_bf16 v[56:71], v[44:47], v[228:231], v[56:71]
    v_mul_f32 v111, v111, v107
    v_cvt_pk_bf16_f32 v118, v108, v109
    v_cvt_pk_bf16_f32 v119, v110, v111
    buffer_store_dwordx4 v[116:119], v1, s[20:23], s65 offen offset:1024 sc1
    s_add_u32 s65, s65, 4096
    ds_read_b64_tr_b16 v[44:45], v5 offset:30720
    ds_read_b64_tr_b16 v[46:47], v5 offset:31232
    s_waitcnt lgkmcnt(6)
    v_mfma_f32_32x32x16_bf16 v[56:71], v[48:51], v[232:235], v[56:71]
    ds_read_b64_tr_b16 v[48:49], v5 offset:32768
    ds_read_b64_tr_b16 v[50:51], v5 offset:33280
    s_waitcnt lgkmcnt(6)
    v_mfma_f32_32x32x16_bf16 v[72:87], v[52:55], v[236:239], v[56:71]
    s_waitcnt vmcnt(2)
    s_barrier
    ds_read_b64_tr_b16 v[52:53], v5 offset:34816
    ds_read_b64_tr_b16 v[54:55], v5 offset:35328
    s_waitcnt lgkmcnt(6)
    v_mfma_f32_32x32x16_bf16 v[56:71], v[40:43], v[128:131], 0
    ds_read_b64_tr_b16 v[40:41], v5 offset:36864
    ds_read_b64_tr_b16 v[42:43], v5 offset:37376
    s_waitcnt lgkmcnt(6)
    v_mfma_f32_32x32x16_bf16 v[56:71], v[44:47], v[132:135], v[56:71]
    v_and_b32 v240, 63, v0
    s_and_b32 s36, s30, 1
    s_lshr_b32 s37, s30, 1
    ds_read_b64_tr_b16 v[44:45], v5 offset:38912
    ds_read_b64_tr_b16 v[46:47], v5 offset:39424
    s_waitcnt lgkmcnt(6)
    v_mfma_f32_32x32x16_bf16 v[56:71], v[48:51], v[136:139], v[56:71]
    s_and_b32 s31, s2, 15
    s_lshr_b32 s32, s2, 4
    s_lshr_b32 s58, s2, 3
    s_mul_i32 s59, s58, 37
    s_lshr_b32 s59, s59, 8
    s_mul_i32 s60, s59, 7
    s_sub_u32 s34, s58, s60
    ds_read_b64_tr_b16 v[48:49], v5 offset:40960
    ds_read_b64_tr_b16 v[50:51], v5 offset:41472
    s_waitcnt lgkmcnt(6)
    v_mfma_f32_32x32x16_bf16 v[56:71], v[52:55], v[140:143], v[56:71]
    s_and_b32 s33, s2, 7
    s_lshl_b32 s33, s33, 2
    s_add_u32 s33, s33, s59
    s_cmp_lt_u32 s2, 224
    s_cselect_b32 s35, 1, 0
    ds_read_b64_tr_b16 v[52:53], v5 offset:43008
    ds_read_b64_tr_b16 v[54:55], v5 offset:43520
    s_waitcnt lgkmcnt(6)
    v_mfma_f32_32x32x16_bf16 v[56:71], v[40:43], v[144:147], v[56:71]
    s_and_b32 s59, s31, 14
    s_mov_b32 s61, s59
    s_add_u32 s60, s59, 1
    v_and_b32 v241, 15, v240
    v_lshlrev_b32 v241, 4, v241
    v_add_u32 v242, s61, v241
    v_add_u32 v243, s60, v241
    v_cmp_gt_u32 vcc, 16, v240
    s_nop 1
    v_cndmask_b32 v242, v243, v242, vcc
    s_lshl_b32 s58, s32, 4
    s_add_u32 s58, s58, s59
    v_mov_b32 v243, s58
    v_cmp_gt_u32 vcc, 32, v240
    s_nop 1
    v_cndmask_b32 v242, v243, v242, vcc
    v_lshlrev_b32 v252, 2, v242
    s_mov_b32 s47, 16782336
    ds_read_b64_tr_b16 v[40:41], v5 offset:45056
    ds_read_b64_tr_b16 v[42:43], v5 offset:45568
    s_waitcnt lgkmcnt(6)
    v_mfma_f32_32x32x16_bf16 v[56:71], v[44:47], v[148:151], v[56:71]
    s_lshl_b32 s40, s31, 18
    s_lshl_b32 s41, s30, 11
    s_add_u32 s40, s40, s41
    s_add_u32 s40, s40, 2097152
    ds_read_b64_tr_b16 v[44:45], v5 offset:47104
    ds_read_b64_tr_b16 v[46:47], v5 offset:47616
    s_waitcnt lgkmcnt(6)
    v_mfma_f32_32x32x16_bf16 v[56:71], v[48:51], v[152:155], v[56:71]
    s_lshl_b32 s59, s32, 2
    s_lshl_b32 s60, s36, 1
    s_add_u32 s59, s59, s60
    s_lshr_b32 s60, s37, 1
    s_add_u32 s59, s59, s60
    s_lshl_b32 s48, s59, 5
    s_lshl_b32 s60, s31, 1
    s_add_u32 s48, s48, s60
    s_and_b32 s60, s37, 1
    s_add_u32 s48, s48, s60
    s_lshl_b32 s48, s48, 10
    s_add_u32 s48, s48, 14680064
    ds_read_b64_tr_b16 v[48:49], v5 offset:49152
    ds_read_b64_tr_b16 v[50:51], v5 offset:49664
    s_waitcnt lgkmcnt(6)
    v_mfma_f32_32x32x16_bf16 v[56:71], v[52:55], v[156:159], v[56:71]
    s_mov_b32 s8, s28
    s_mov_b32 s9, s29
    s_mov_b32 s10, 1605632
    s_mov_b32 s11, 0x20000
    ds_read_b64_tr_b16 v[52:53], v5 offset:51200
    ds_read_b64_tr_b16 v[54:55], v5 offset:51712
    s_waitcnt lgkmcnt(6)
    v_mfma_f32_32x32x16_bf16 v[56:71], v[40:43], v[160:163], v[56:71]
    s_waitcnt lgkmcnt(0)
    s_mov_b32 s12, s4
    s_mov_b32 s13, s5
    s_mov_b32 s14, 401408
    s_mov_b32 s15, 0x20000
    ds_read_b64_tr_b16 v[40:41], v5 offset:53248
    ds_read_b64_tr_b16 v[42:43], v5 offset:53760
    v_mfma_f32_32x32x16_bf16 v[56:71], v[44:47], v[164:167], v[56:71]
    s_mov_b32 s16, s38
    s_mov_b32 s17, s39
    s_mov_b32 s18, 1835008
    s_mov_b32 s19, 0x20000
    ds_read_b64_tr_b16 v[44:45], v5 offset:55296
    ds_read_b64_tr_b16 v[46:47], v5 offset:55808
    v_mfma_f32_32x32x16_bf16 v[56:71], v[48:51], v[168:171], v[56:71]
    s_lshl_b32 s58, s37, 12
    v_add_u32 v2, s58, v1
    v_and_b32 v244, 31, v0
    v_bfe_u32 v245, v0, 5, 1
    ds_read_b64_tr_b16 v[48:49], v6 offset:0
    ds_read_b64_tr_b16 v[50:51], v6 offset:512
    v_mfma_f32_32x32x16_bf16 v[56:71], v[52:55], v[172:175], v[56:71]
    v_lshrrev_b32 v246, 3, v240
    v_mul_u32_u24 v246, 896, v246
    v_bfe_u32 v247, v240, 4, 1
    ds_read_b64_tr_b16 v[52:53], v6 offset:2048
    ds_read_b64_tr_b16 v[54:55], v6 offset:2560
    s_waitcnt lgkmcnt(6)
    v_mfma_f32_32x32x16_bf16 v[56:71], v[40:43], v[176:179], v[56:71]
    v_lshlrev_b32 v247, 2, v247
    v_and_b32 v248, 7, v240
    v_xor_b32 v247, v247, v248
    ds_read_b64_tr_b16 v[40:41], v6 offset:4096
    ds_read_b64_tr_b16 v[42:43], v6 offset:4608
    s_waitcnt lgkmcnt(6)
    v_mfma_f32_32x32x16_bf16 v[56:71], v[44:47], v[180:183], v[56:71]
    v_lshlrev_b32 v247, 4, v247
    v_add_u32 v16, v246, v247
    ds_read_b64_tr_b16 v[44:45], v6 offset:6144
    ds_read_b64_tr_b16 v[46:47], v6 offset:6656
    s_waitcnt lgkmcnt(6)
    v_mfma_f32_32x32x16_bf16 v[56:71], v[48:51], v[184:187], v[56:71]
    s_cmp_lt_u32 s30, 4
    s_cbranch_scc0 parallel_sum__softmax_full_mha__swiglu_ffn__prompt_kernel_bx_setB
    v_mov_b32 v12, v1
    v_mov_b32 v13, v1
    v_mov_b32 v14, v1
    v_mov_b32 v15, v1
    s_lshr_b32 s60, s30, 1
    s_lshl_b32 s58, s33, 1
    s_add_u32 s58, s58, s60
    s_mul_i32 s42, s58, 114688
    s_and_b32 s61, s30, 1
    s_lshl_b32 s61, s61, 12
    s_add_u32 s42, s42, s61
    s_add_u32 s42, s42, 6291456
    s_mov_b32 s44, 8192
    s_lshl_b32 s43, s60, 13
    s_add_u32 s43, s43, s61
    s_mov_b64 s[76:77], s[20:21]
    s_mov_b32 s78, 20971520
    s_branch parallel_sum__softmax_full_mha__swiglu_ffn__prompt_kernel_bx_setC
parallel_sum__softmax_full_mha__swiglu_ffn__prompt_kernel_bx_setB:
    v_add_u32 v12, 0, v16
    v_add_u32 v13, 6144, v16
    v_add_u32 v14, 12288, v16
    v_add_u32 v15, 18432, v16
    s_sub_u32 s58, s30, 4
    s_mul_i32 s42, s58, 28672
    s_lshl_b32 s59, s34, 7
    s_add_u32 s42, s42, s59
    s_mov_b32 s44, 114688
    s_lshl_b32 s43, s58, 12
    s_add_u32 s43, s43, 16384
    s_mov_b64 s[76:77], s[8:9]
    s_mov_b32 s78, 1605632
parallel_sum__softmax_full_mha__swiglu_ffn__prompt_kernel_bx_setC:
    s_mov_b32 s79, 0x20000
    s_add_u32 s43, s43, 49152
    ds_read_b64_tr_b16 v[48:49], v6 offset:8192
    ds_read_b64_tr_b16 v[50:51], v6 offset:8704
    s_waitcnt lgkmcnt(6)
    v_mfma_f32_32x32x16_bf16 v[56:71], v[52:55], v[188:191], v[56:71]
    s_lshl_b32 s58, s33, 6
    s_lshr_b32 s59, s37, 1
    s_lshl_b32 s59, s59, 5
    s_add_u32 s58, s58, s59
    s_mul_i32 s58, s58, 896
    s_lshl_b32 s59, s34, 7
    s_lshl_b32 s60, s36, 6
    s_add_u32 s58, s58, s59
    s_add_u32 s46, s58, s60
    s_and_b32 s58, s37, 1
    s_lshl_b32 s58, s58, 5
    s_add_u32 s46, s46, s58
    ds_read_b64_tr_b16 v[52:53], v6 offset:10240
    ds_read_b64_tr_b16 v[54:55], v6 offset:10752
    s_waitcnt lgkmcnt(6)
    v_mfma_f32_32x32x16_bf16 v[56:71], v[40:43], v[192:195], v[56:71]
    buffer_load_dword v253, v252, s[20:23], s47 offen sc1
    ds_read_b64_tr_b16 v[40:41], v6 offset:12288
    ds_read_b64_tr_b16 v[42:43], v6 offset:12800
    s_waitcnt lgkmcnt(6)
    v_mfma_f32_32x32x16_bf16 v[56:71], v[44:47], v[196:199], v[56:71]
    v_mul_u32_u24 v18, 896, v244
    v_lshlrev_b32 v246, 4, v245
    v_add_u32 v18, v18, v246
    ds_read_b64_tr_b16 v[44:45], v6 offset:14336
    ds_read_b64_tr_b16 v[46:47], v6 offset:14848
    s_waitcnt lgkmcnt(6)
    v_mfma_f32_32x32x16_bf16 v[56:71], v[48:51], v[200:203], v[56:71]
    v_bfe_u32 v246, v240, 2, 2
    v_lshlrev_b32 v247, 2, v245
    v_add_u32 v247, v247, v246
    v_lshlrev_b32 v17, 7, v247
    ds_read_b64_tr_b16 v[48:49], v6 offset:16384
    ds_read_b64_tr_b16 v[50:51], v6 offset:16896
    s_waitcnt lgkmcnt(6)
    v_mfma_f32_32x32x16_bf16 v[56:71], v[52:55], v[204:207], v[56:71]
    v_lshrrev_b32 v246, 1, v246
    v_xor_b32 v246, s36, v246
    v_lshlrev_b32 v246, 6, v246
    v_add_u32 v17, v17, v246
    ds_read_b64_tr_b16 v[52:53], v6 offset:18432
    ds_read_b64_tr_b16 v[54:55], v6 offset:18944
    s_waitcnt lgkmcnt(6)
    v_mfma_f32_32x32x16_bf16 v[56:71], v[40:43], v[208:211], v[56:71]
    v_bfe_u32 v246, v240, 4, 1
    v_lshlrev_b32 v246, 5, v246
    v_add_u32 v17, v17, v246
    ds_read_b64_tr_b16 v[40:41], v6 offset:20480
    ds_read_b64_tr_b16 v[42:43], v6 offset:20992
    s_waitcnt lgkmcnt(6)
    v_mfma_f32_32x32x16_bf16 v[56:71], v[44:47], v[212:215], v[56:71]
    v_and_b32 v246, 3, v240
    v_lshlrev_b32 v246, 3, v246
    v_add_u32 v17, v17, v246
    ds_read_b64_tr_b16 v[44:45], v6 offset:22528
    ds_read_b64_tr_b16 v[46:47], v6 offset:23040
    s_waitcnt lgkmcnt(6)
    v_mfma_f32_32x32x16_bf16 v[56:71], v[48:51], v[216:219], v[56:71]
    s_lshl_b32 s58, s37, 11
    s_add_u32 s58, s58, 49152
    v_add_u32 v3, s58, v1
    s_lshl_b32 s59, s37, 12
    s_add_u32 s59, s59, 65536
    v_add_u32 v9, s59, v17
    ds_read_b64_tr_b16 v[48:49], v6 offset:24576
    ds_read_b64_tr_b16 v[50:51], v6 offset:25088
    s_waitcnt lgkmcnt(6)
    v_mfma_f32_32x32x16_bf16 v[56:71], v[52:55], v[220:223], v[56:71]
    s_lshl_b32 s58, s37, 11
    s_add_u32 s58, s58, 81920
    v_add_u32 v4, s58, v1
    s_lshl_b32 s59, s37, 12
    s_add_u32 s59, s59, 98304
    v_add_u32 v10, s59, v17
    ds_read_b64_tr_b16 v[52:53], v6 offset:26624
    ds_read_b64_tr_b16 v[54:55], v6 offset:27136
    s_waitcnt lgkmcnt(6)
    v_mfma_f32_32x32x16_bf16 v[56:71], v[40:43], v[224:227], v[56:71]
    s_lshl_b32 s58, s37, 11
    s_add_u32 s58, s58, 114688
    v_add_u32 v8, s58, v1
    s_lshl_b32 s59, s37, 12
    s_add_u32 s59, s59, 131072
    v_add_u32 v11, s59, v17
    s_waitcnt lgkmcnt(4)
    v_mfma_f32_32x32x16_bf16 v[56:71], v[44:47], v[228:231], v[56:71]
    s_lshl_b32 s50, s34, 7
    s_mul_i32 s58, s30, 7168
    s_add_u32 s50, s50, s58
    s_lshl_b32 s51, s30, 10
    s_lshl_b32 s58, s31, 6
    s_lshl_b32 s59, s32, 2
    s_add_u32 s58, s58, s59
    s_lshl_b32 s58, s58, 11
    s_lshl_b32 s59, s30, 10
    s_add_u32 s58, s58, s59
    s_add_u32 s53, s58, 0
    s_waitcnt lgkmcnt(2)
    v_mfma_f32_32x32x16_bf16 v[56:71], v[48:51], v[232:235], v[56:71]
    s_waitcnt lgkmcnt(0)
    v_mfma_f32_32x32x16_bf16 v[88:103], v[52:55], v[236:239], v[56:71]
    s_barrier
    s_mov_b32 s49, 0x200000
parallel_sum__softmax_full_mha__swiglu_ffn__prompt_kernel_bx_kvchk:
    s_waitcnt vmcnt(0)
    v_cmp_eq_u32 vcc, s3, v253
    s_nop 0
    s_cmp_eq_u64 vcc, -1
    s_cbranch_scc1 parallel_sum__softmax_full_mha__swiglu_ffn__prompt_kernel_bx_kvok
    buffer_load_dword v253, v252, s[20:23], s47 offen sc1
    s_waitcnt vmcnt(0)
    s_sub_u32 s49, s49, 1
    s_cmp_lg_u32 s49, 0
    s_cbranch_scc1 parallel_sum__softmax_full_mha__swiglu_ffn__prompt_kernel_bx_kvchk
parallel_sum__softmax_full_mha__swiglu_ffn__prompt_kernel_bx_kvok:
    s_add_u32 m0, s41, 0
    s_add_u32 s45, s40, 0
    buffer_load_dwordx4 v1, s[20:23], s45 offen sc1 lds
    buffer_load_dwordx4 v1, s[20:23], s45 offen offset:1024 sc1 lds
    s_lshl_b32 s58, s30, 10
    s_add_u32 m0, s58, 49152
    s_nop 0
    buffer_load_dwordx4 v1, s[20:23], s53 offen sc1 lds
    s_nop 4
    v_mul_f32 v104, 0xbfb8aa3b, v72
    v_mul_f32 v105, 0xbfb8aa3b, v73
    v_mul_f32 v106, 0xbfb8aa3b, v74
    v_mul_f32 v107, 0xbfb8aa3b, v75
    v_exp_f32 v104, v104
    v_mul_f32 v108, v72, v88
    v_exp_f32 v105, v105
    v_mul_f32 v109, v73, v89
    v_exp_f32 v106, v106
    v_mul_f32 v110, v74, v90
    v_exp_f32 v107, v107
    v_mul_f32 v111, v75, v91
    v_add_f32 v104, 1.0, v104
    v_add_f32 v105, 1.0, v105
    v_add_f32 v106, 1.0, v106
    v_add_f32 v107, 1.0, v107
    v_rcp_f32 v104, v104
    v_rcp_f32 v105, v105
    v_rcp_f32 v106, v106
    v_rcp_f32 v107, v107
    v_mul_f32 v108, v108, v104
    v_mul_f32 v109, v109, v105
    v_mul_f32 v110, v110, v106
    v_mul_f32 v111, v111, v107
    v_cvt_pk_bf16_f32 v112, v108, v109
    v_cvt_pk_bf16_f32 v113, v110, v111
    v_mul_f32 v104, 0xbfb8aa3b, v76
    v_mul_f32 v105, 0xbfb8aa3b, v77
    v_mul_f32 v106, 0xbfb8aa3b, v78
    v_mul_f32 v107, 0xbfb8aa3b, v79
    v_exp_f32 v104, v104
    v_mul_f32 v108, v76, v92
    v_exp_f32 v105, v105
    v_mul_f32 v109, v77, v93
    v_exp_f32 v106, v106
    v_mul_f32 v110, v78, v94
    v_exp_f32 v107, v107
    v_mul_f32 v111, v79, v95
    v_add_f32 v104, 1.0, v104
    v_add_f32 v105, 1.0, v105
    v_add_f32 v106, 1.0, v106
    v_add_f32 v107, 1.0, v107
    v_rcp_f32 v104, v104
    v_rcp_f32 v105, v105
    v_rcp_f32 v106, v106
    v_rcp_f32 v107, v107
    v_mul_f32 v108, v108, v104
    v_mul_f32 v109, v109, v105
    v_mul_f32 v110, v110, v106
    v_mul_f32 v111, v111, v107
    v_cvt_pk_bf16_f32 v114, v108, v109
    v_cvt_pk_bf16_f32 v115, v110, v111
    buffer_store_dwordx4 v[112:115], v1, s[20:23], s65 offen offset:0 sc1
    v_mul_f32 v104, 0xbfb8aa3b, v80
    v_mul_f32 v105, 0xbfb8aa3b, v81
    v_mul_f32 v106, 0xbfb8aa3b, v82
    v_mul_f32 v107, 0xbfb8aa3b, v83
    v_exp_f32 v104, v104
    v_mul_f32 v108, v80, v96
    v_exp_f32 v105, v105
    v_mul_f32 v109, v81, v97
    v_exp_f32 v106, v106
    v_mul_f32 v110, v82, v98
    v_exp_f32 v107, v107
    v_mul_f32 v111, v83, v99
    v_add_f32 v104, 1.0, v104
    v_add_f32 v105, 1.0, v105
    v_add_f32 v106, 1.0, v106
    v_add_f32 v107, 1.0, v107
    v_rcp_f32 v104, v104
    v_rcp_f32 v105, v105
    v_rcp_f32 v106, v106
    v_rcp_f32 v107, v107
    v_mul_f32 v108, v108, v104
    v_mul_f32 v109, v109, v105
    v_mul_f32 v110, v110, v106
    v_mul_f32 v111, v111, v107
    v_cvt_pk_bf16_f32 v116, v108, v109
    v_cvt_pk_bf16_f32 v117, v110, v111
    v_mul_f32 v104, 0xbfb8aa3b, v84
    v_mul_f32 v105, 0xbfb8aa3b, v85
    v_mul_f32 v106, 0xbfb8aa3b, v86
    v_mul_f32 v107, 0xbfb8aa3b, v87
    v_exp_f32 v104, v104
    v_mul_f32 v108, v84, v100
    v_exp_f32 v105, v105
    v_mul_f32 v109, v85, v101
    v_exp_f32 v106, v106
    v_mul_f32 v110, v86, v102
    v_exp_f32 v107, v107
    v_mul_f32 v111, v87, v103
    v_add_f32 v104, 1.0, v104
    v_add_f32 v105, 1.0, v105
    v_add_f32 v106, 1.0, v106
    v_add_f32 v107, 1.0, v107
    v_rcp_f32 v104, v104
    v_rcp_f32 v105, v105
    v_rcp_f32 v106, v106
    v_rcp_f32 v107, v107
    v_mul_f32 v108, v108, v104
    v_mul_f32 v109, v109, v105
    v_mul_f32 v110, v110, v106
    v_mul_f32 v111, v111, v107
    v_cvt_pk_bf16_f32 v118, v108, v109
    v_cvt_pk_bf16_f32 v119, v110, v111
    buffer_store_dwordx4 v[116:119], v1, s[20:23], s65 offen offset:1024 sc1
    s_add_u32 s65, s65, 4096
    s_branch parallel_sum__softmax_full_mha__swiglu_ffn__prompt_kernel_a_fin
parallel_sum__softmax_full_mha__swiglu_ffn__prompt_kernel_a_seqA:
    s_waitcnt vmcnt(4) lgkmcnt(0)
    s_barrier
    ds_read_b128 v[128:131], v240 offset:0
    ds_read_b64_tr_b16 v[40:41], v4 offset:0
    ds_read_b64_tr_b16 v[42:43], v4 offset:512
    ds_read_b128 v[132:135], v241 offset:0
    ds_read_b64_tr_b16 v[44:45], v4 offset:2048
    ds_read_b64_tr_b16 v[46:47], v4 offset:2560
    ds_read_b128 v[136:139], v242 offset:0
    ds_read_b64_tr_b16 v[48:49], v4 offset:4096
    ds_read_b64_tr_b16 v[50:51], v4 offset:4608
    ds_read_b128 v[140:143], v243 offset:0
    ds_read_b128 v[144:147], v240 offset:16384
    ds_read_b128 v[148:151], v241 offset:16384
    ds_read_b128 v[152:155], v242 offset:16384
    ds_read_b128 v[156:159], v243 offset:16384
    ds_read_b128 v[160:163], v240 offset:32768
    ds_read_b128 v[164:167], v241 offset:32768
    ds_read_b64_tr_b16 v[52:53], v4 offset:6144
    ds_read_b64_tr_b16 v[54:55], v4 offset:6656
    s_waitcnt lgkmcnt(15)
    v_mfma_f32_32x32x16_bf16 v[56:71], v[40:43], v[128:131], 0
    s_waitcnt vmcnt(2) lgkmcnt(8)
    s_barrier
    s_add_u32 m0, s49, 0
    s_add_u32 s61, s50, 0
    buffer_load_dwordx4 v8, s[8:11], s47 offen lds
    s_mov_b32 m0, s61
    s_add_u32 s47, s47, 301056
    buffer_load_dwordx4 v8, s[8:11], s48 offen lds
    s_add_u32 s48, s48, 301056
    ds_read_b128 v[168:171], v242 offset:32768
    ds_read_b128 v[172:175], v243 offset:32768
    ds_read_b128 v[176:179], v240 offset:49152
    ds_read_b128 v[180:183], v241 offset:49152
    ds_read_b64_tr_b16 v[40:41], v4 offset:8192
    ds_read_b64_tr_b16 v[42:43], v4 offset:8704
    v_mfma_f32_32x32x16_bf16 v[56:71], v[44:47], v[132:135], v[56:71]
    ds_read_b128 v[184:187], v242 offset:49152
    ds_read_b128 v[188:191], v243 offset:49152
    v_add_u32 v240, 0x10000, v240
    v_add_u32 v241, 0x10000, v241
    v_add_u32 v242, 0x10000, v242
    v_add_u32 v243, 0x10000, v243
    ds_read_b128 v[192:195], v240 offset:0
    ds_read_b128 v[196:199], v241 offset:0
    ds_read_b64_tr_b16 v[44:45], v4 offset:10240
    ds_read_b64_tr_b16 v[46:47], v4 offset:10752
    v_mfma_f32_32x32x16_bf16 v[56:71], v[48:51], v[136:139], v[56:71]
    ds_read_b128 v[200:203], v242 offset:0
    ds_read_b128 v[204:207], v243 offset:0
    ds_read_b128 v[208:211], v240 offset:16384
    ds_read_b128 v[212:215], v241 offset:16384
    ds_read_b64_tr_b16 v[48:49], v4 offset:12288
    ds_read_b64_tr_b16 v[50:51], v4 offset:12800
    s_waitcnt lgkmcnt(15)
    v_mfma_f32_32x32x16_bf16 v[56:71], v[52:55], v[140:143], v[56:71]
    ds_read_b128 v[216:219], v242 offset:16384
    ds_read_b128 v[220:223], v243 offset:16384
    ds_read_b128 v[224:227], v240 offset:32768
    ds_read_b128 v[228:231], v241 offset:32768
    ds_read_b64_tr_b16 v[52:53], v4 offset:14336
    ds_read_b64_tr_b16 v[54:55], v4 offset:14848
    s_waitcnt lgkmcnt(15)
    v_mfma_f32_32x32x16_bf16 v[56:71], v[40:43], v[144:147], v[56:71]
    ds_read_b128 v[232:235], v242 offset:32768
    ds_read_b128 v[236:239], v243 offset:32768
    ds_read_b64_tr_b16 v[40:41], v4 offset:16384
    ds_read_b64_tr_b16 v[42:43], v4 offset:16896
    s_waitcnt lgkmcnt(15)
    v_mfma_f32_32x32x16_bf16 v[56:71], v[44:47], v[148:151], v[56:71]
    s_waitcnt lgkmcnt(2)
    s_barrier
    s_add_u32 s47, s41, s45
    s_add_u32 s48, s47, s51
    s_add_u32 m0, s49, 14336
    s_add_u32 s61, s50, 14336
    buffer_load_dwordx4 v8, s[8:11], s47 offen lds
    s_mov_b32 m0, s61
    s_add_u32 s47, s47, 301056
    buffer_load_dwordx4 v8, s[8:11], s48 offen lds
    s_add_u32 s48, s48, 301056
    ds_read_b64_tr_b16 v[44:45], v4 offset:18432
    ds_read_b64_tr_b16 v[46:47], v4 offset:18944
    v_mfma_f32_32x32x16_bf16 v[56:71], v[48:51], v[152:155], v[56:71]
    ds_read_b64_tr_b16 v[48:49], v4 offset:20480
    ds_read_b64_tr_b16 v[50:51], v4 offset:20992
    v_mfma_f32_32x32x16_bf16 v[56:71], v[52:55], v[156:159], v[56:71]
    ds_read_b64_tr_b16 v[52:53], v4 offset:22528
    ds_read_b64_tr_b16 v[54:55], v4 offset:23040
    s_waitcnt lgkmcnt(6)
    v_mfma_f32_32x32x16_bf16 v[56:71], v[40:43], v[160:163], v[56:71]
    ds_read_b64_tr_b16 v[40:41], v4 offset:24576
    ds_read_b64_tr_b16 v[42:43], v4 offset:25088
    s_waitcnt lgkmcnt(6)
    v_mfma_f32_32x32x16_bf16 v[56:71], v[44:47], v[164:167], v[56:71]
    s_add_u32 m0, s49, 28672
    s_add_u32 s61, s50, 28672
    buffer_load_dwordx4 v8, s[8:11], s47 offen lds
    s_mov_b32 m0, s61
    s_add_u32 s47, s47, 301056
    buffer_load_dwordx4 v8, s[8:11], s48 offen lds
    s_add_u32 s48, s48, 301056
    ds_read_b64_tr_b16 v[44:45], v4 offset:26624
    ds_read_b64_tr_b16 v[46:47], v4 offset:27136
    s_waitcnt lgkmcnt(6)
    v_mfma_f32_32x32x16_bf16 v[56:71], v[48:51], v[168:171], v[56:71]
    s_waitcnt vmcnt(6)
    s_barrier
    ds_read_b64_tr_b16 v[48:49], v4 offset:28672
    ds_read_b64_tr_b16 v[50:51], v4 offset:29184
    s_waitcnt lgkmcnt(6)
    v_mfma_f32_32x32x16_bf16 v[56:71], v[52:55], v[172:175], v[56:71]
    ds_read_b64_tr_b16 v[52:53], v4 offset:30720
    ds_read_b64_tr_b16 v[54:55], v4 offset:31232
    s_waitcnt lgkmcnt(6)
    v_mfma_f32_32x32x16_bf16 v[56:71], v[40:43], v[176:179], v[56:71]
    ds_read_b64_tr_b16 v[40:41], v4 offset:32768
    ds_read_b64_tr_b16 v[42:43], v4 offset:33280
    s_waitcnt lgkmcnt(6)
    v_mfma_f32_32x32x16_bf16 v[56:71], v[44:47], v[180:183], v[56:71]
    s_add_u32 m0, s49, 43008
    s_add_u32 s61, s50, 43008
    buffer_load_dwordx4 v8, s[8:11], s47 offen lds
    s_mov_b32 m0, s61
    s_add_u32 s47, s47, 301056
    buffer_load_dwordx4 v8, s[8:11], s48 offen lds
    s_add_u32 s48, s48, 301056
    ds_read_b64_tr_b16 v[44:45], v4 offset:34816
    ds_read_b64_tr_b16 v[46:47], v4 offset:35328
    s_waitcnt lgkmcnt(6)
    v_mfma_f32_32x32x16_bf16 v[56:71], v[48:51], v[184:187], v[56:71]
    ds_read_b64_tr_b16 v[48:49], v4 offset:36864
    ds_read_b64_tr_b16 v[50:51], v4 offset:37376
    s_waitcnt lgkmcnt(6)
    v_mfma_f32_32x32x16_bf16 v[56:71], v[52:55], v[188:191], v[56:71]
    ds_read_b64_tr_b16 v[52:53], v4 offset:38912
    ds_read_b64_tr_b16 v[54:55], v4 offset:39424
    s_waitcnt lgkmcnt(6)
    v_mfma_f32_32x32x16_bf16 v[56:71], v[40:43], v[192:195], v[56:71]
    ds_read_b64_tr_b16 v[40:41], v4 offset:40960
    ds_read_b64_tr_b16 v[42:43], v4 offset:41472
    s_waitcnt lgkmcnt(6)
    v_mfma_f32_32x32x16_bf16 v[56:71], v[44:47], v[196:199], v[56:71]
    s_waitcnt vmcnt(6)
    s_barrier
    ds_read_b64_tr_b16 v[44:45], v2 offset:0
    ds_read_b64_tr_b16 v[46:47], v2 offset:512
    s_waitcnt lgkmcnt(6)
    v_mfma_f32_32x32x16_bf16 v[56:71], v[48:51], v[200:203], v[56:71]
    s_add_u32 m0, s49, 57344
    s_add_u32 s61, s50, 57344
    buffer_load_dwordx4 v8, s[8:11], s47 offen lds
    s_mov_b32 m0, s61
    s_add_u32 s47, s47, 301056
    buffer_load_dwordx4 v8, s[8:11], s48 offen lds
    s_add_u32 s48, s48, 301056
    ds_read_b64_tr_b16 v[48:49], v2 offset:2048
    ds_read_b64_tr_b16 v[50:51], v2 offset:2560
    s_waitcnt lgkmcnt(6)
    v_mfma_f32_32x32x16_bf16 v[56:71], v[52:55], v[204:207], v[56:71]
    ds_read_b64_tr_b16 v[52:53], v2 offset:4096
    ds_read_b64_tr_b16 v[54:55], v2 offset:4608
    s_waitcnt lgkmcnt(6)
    v_mfma_f32_32x32x16_bf16 v[56:71], v[40:43], v[208:211], v[56:71]
    ds_read_b64_tr_b16 v[40:41], v2 offset:6144
    ds_read_b64_tr_b16 v[42:43], v2 offset:6656
    s_waitcnt lgkmcnt(6)
    v_mfma_f32_32x32x16_bf16 v[56:71], v[44:47], v[212:215], v[56:71]
    ds_read_b64_tr_b16 v[44:45], v2 offset:8192
    ds_read_b64_tr_b16 v[46:47], v2 offset:8704
    s_waitcnt lgkmcnt(6)
    v_mfma_f32_32x32x16_bf16 v[56:71], v[48:51], v[216:219], v[56:71]
    ds_read_b64_tr_b16 v[48:49], v2 offset:10240
    ds_read_b64_tr_b16 v[50:51], v2 offset:10752
    s_waitcnt lgkmcnt(6)
    v_mfma_f32_32x32x16_bf16 v[56:71], v[52:55], v[220:223], v[56:71]
    s_add_u32 s47, s42, s46
    s_add_u32 s48, s47, s52
    s_add_u32 m0, s49, 71680
    s_add_u32 s61, s50, 71680
    buffer_load_dwordx4 v9, s[12:15], s47 offen lds
    s_mov_b32 m0, s61
    s_add_u32 s47, s47, 401408
    buffer_load_dwordx4 v9, s[12:15], s48 offen lds
    s_add_u32 s48, s48, 401408
    ds_read_b64_tr_b16 v[52:53], v2 offset:12288
    ds_read_b64_tr_b16 v[54:55], v2 offset:12800
    s_waitcnt lgkmcnt(6)
    v_mfma_f32_32x32x16_bf16 v[56:71], v[40:43], v[224:227], v[56:71]
    s_waitcnt vmcnt(8)
    s_barrier
    ds_read_b64_tr_b16 v[40:41], v2 offset:14336
    ds_read_b64_tr_b16 v[42:43], v2 offset:14848
    s_waitcnt lgkmcnt(6)
    v_mfma_f32_32x32x16_bf16 v[56:71], v[44:47], v[228:231], v[56:71]
    ds_read_b64_tr_b16 v[44:45], v2 offset:16384
    ds_read_b64_tr_b16 v[46:47], v2 offset:16896
    s_waitcnt lgkmcnt(6)
    v_mfma_f32_32x32x16_bf16 v[56:71], v[48:51], v[232:235], v[56:71]
    ds_read_b64_tr_b16 v[48:49], v2 offset:18432
    ds_read_b64_tr_b16 v[50:51], v2 offset:18944
    s_waitcnt lgkmcnt(6)
    v_mfma_f32_32x32x16_bf16 v[88:103], v[52:55], v[236:239], v[56:71]
    ds_read_b64_tr_b16 v[52:53], v2 offset:20480
    ds_read_b64_tr_b16 v[54:55], v2 offset:20992
    s_waitcnt lgkmcnt(6)
    v_mfma_f32_32x32x16_bf16 v[56:71], v[40:43], v[128:131], 0
    ds_read_b64_tr_b16 v[40:41], v2 offset:22528
    ds_read_b64_tr_b16 v[42:43], v2 offset:23040
    s_waitcnt lgkmcnt(6)
    v_mfma_f32_32x32x16_bf16 v[56:71], v[44:47], v[132:135], v[56:71]
    s_add_u32 m0, s49, 86016
    s_add_u32 s61, s50, 86016
    buffer_load_dwordx4 v9, s[12:15], s47 offen lds
    s_mov_b32 m0, s61
    s_add_u32 s47, s47, 401408
    buffer_load_dwordx4 v9, s[12:15], s48 offen lds
    s_add_u32 s48, s48, 401408
    v_mul_f32 v104, s66, v88
    v_mul_f32 v105, s66, v89
    ds_read_b64_tr_b16 v[44:45], v2 offset:24576
    ds_read_b64_tr_b16 v[46:47], v2 offset:25088
    s_waitcnt lgkmcnt(6)
    v_mfma_f32_32x32x16_bf16 v[56:71], v[48:51], v[136:139], v[56:71]
    v_mul_f32 v106, s66, v90
    v_mul_f32 v107, s66, v91
    ds_read_b64_tr_b16 v[48:49], v2 offset:26624
    ds_read_b64_tr_b16 v[50:51], v2 offset:27136
    s_waitcnt lgkmcnt(6)
    v_mfma_f32_32x32x16_bf16 v[56:71], v[52:55], v[140:143], v[56:71]
    v_mul_f32 v108, s66, v92
    v_mul_f32 v109, s66, v93
    s_waitcnt vmcnt(8)
    s_barrier
    ds_read_b64_tr_b16 v[52:53], v2 offset:28672
    ds_read_b64_tr_b16 v[54:55], v2 offset:29184
    s_waitcnt lgkmcnt(6)
    v_mfma_f32_32x32x16_bf16 v[56:71], v[40:43], v[144:147], v[56:71]
    v_mul_f32 v110, s66, v94
    v_mul_f32 v111, s66, v95
    ds_read_b64_tr_b16 v[40:41], v2 offset:30720
    ds_read_b64_tr_b16 v[42:43], v2 offset:31232
    s_waitcnt lgkmcnt(6)
    v_mfma_f32_32x32x16_bf16 v[56:71], v[44:47], v[148:151], v[56:71]
    s_add_u32 m0, s49, 100352
    s_add_u32 s61, s50, 100352
    buffer_load_dwordx4 v9, s[12:15], s47 offen lds
    s_mov_b32 m0, s61
    s_add_u32 s47, s47, 401408
    buffer_load_dwordx4 v9, s[12:15], s48 offen lds
    s_add_u32 s48, s48, 401408
    v_mul_f32 v112, s66, v96
    v_mul_f32 v113, s66, v97
    ds_read_b64_tr_b16 v[44:45], v2 offset:32768
    ds_read_b64_tr_b16 v[46:47], v2 offset:33280
    s_waitcnt lgkmcnt(6)
    v_mfma_f32_32x32x16_bf16 v[56:71], v[48:51], v[152:155], v[56:71]
    v_mul_f32 v114, s66, v98
    v_mul_f32 v115, s66, v99
    ds_read_b64_tr_b16 v[48:49], v2 offset:34816
    ds_read_b64_tr_b16 v[50:51], v2 offset:35328
    s_waitcnt lgkmcnt(6)
    v_mfma_f32_32x32x16_bf16 v[56:71], v[52:55], v[156:159], v[56:71]
    v_mul_f32 v116, s66, v100
    v_mul_f32 v117, s66, v101
    ds_read_b64_tr_b16 v[52:53], v2 offset:36864
    ds_read_b64_tr_b16 v[54:55], v2 offset:37376
    s_waitcnt lgkmcnt(6)
    v_mfma_f32_32x32x16_bf16 v[56:71], v[40:43], v[160:163], v[56:71]
    v_mul_f32 v118, s66, v102
    v_mul_f32 v119, s66, v103
    ds_read_b64_tr_b16 v[40:41], v2 offset:38912
    ds_read_b64_tr_b16 v[42:43], v2 offset:39424
    s_waitcnt lgkmcnt(6)
    v_mfma_f32_32x32x16_bf16 v[56:71], v[44:47], v[164:167], v[56:71]
    s_add_u32 m0, s49, 114688
    s_add_u32 s61, s50, 114688
    buffer_load_dwordx4 v9, s[12:15], s47 offen lds
    s_mov_b32 m0, s61
    s_add_u32 s47, s47, 401408
    buffer_load_dwordx4 v9, s[12:15], s48 offen lds
    s_add_u32 s48, s48, 401408
    v_cvt_pk_bf16_f32 v120, v104, v105
    v_cvt_pk_bf16_f32 v121, v106, v107
    ds_read_b64_tr_b16 v[44:45], v2 offset:40960
    ds_read_b64_tr_b16 v[46:47], v2 offset:41472
    s_waitcnt lgkmcnt(6)
    v_mfma_f32_32x32x16_bf16 v[56:71], v[48:51], v[168:171], v[56:71]
    v_cvt_pk_bf16_f32 v122, v108, v109
    v_cvt_pk_bf16_f32 v123, v110, v111
    s_waitcnt vmcnt(10)
    s_barrier
    ds_read_b64_tr_b16 v[48:49], v2 offset:43008
    ds_read_b64_tr_b16 v[50:51], v2 offset:43520
    s_waitcnt lgkmcnt(6)
    v_mfma_f32_32x32x16_bf16 v[56:71], v[52:55], v[172:175], v[56:71]
    v_cvt_pk_bf16_f32 v124, v112, v113
    v_cvt_pk_bf16_f32 v125, v114, v115
    ds_read_b64_tr_b16 v[52:53], v2 offset:45056
    ds_read_b64_tr_b16 v[54:55], v2 offset:45568
    s_waitcnt lgkmcnt(6)
    v_mfma_f32_32x32x16_bf16 v[56:71], v[40:43], v[176:179], v[56:71]
    v_cvt_pk_bf16_f32 v126, v116, v117
    v_cvt_pk_bf16_f32 v127, v118, v119
    ds_read_b64_tr_b16 v[40:41], v2 offset:47104
    ds_read_b64_tr_b16 v[42:43], v2 offset:47616
    s_waitcnt lgkmcnt(6)
    v_mfma_f32_32x32x16_bf16 v[56:71], v[44:47], v[180:183], v[56:71]
    s_add_u32 s47, s43, s46
    s_add_u32 s48, s47, s52
    s_add_u32 m0, s49, 129024
    s_add_u32 s61, s50, 129024
    buffer_load_dwordx4 v9, s[16:19], s47 offen lds
    s_mov_b32 m0, s61
    s_add_u32 s47, s47, 401408
    buffer_load_dwordx4 v9, s[16:19], s48 offen lds
    s_add_u32 s48, s48, 401408
    v_mov_b32 v104, s67
    v_mov_b32 v105, 0
    ds_read_b64_tr_b16 v[44:45], v2 offset:49152
    ds_read_b64_tr_b16 v[46:47], v2 offset:49664
    s_waitcnt lgkmcnt(6)
    v_mfma_f32_32x32x16_bf16 v[56:71], v[48:51], v[184:187], v[56:71]
    v_cndmask_b32 v126, v126, v104, s[54:55]
    v_cndmask_b32 v127, v127, v105, s[54:55]
    ds_read_b64_tr_b16 v[48:49], v2 offset:51200
    ds_read_b64_tr_b16 v[50:51], v2 offset:51712
    s_waitcnt lgkmcnt(6)
    v_mfma_f32_32x32x16_bf16 v[56:71], v[52:55], v[188:191], v[56:71]
    buffer_store_dwordx4 v[120:123], v1, s[20:23], s62 offen sc1
    buffer_store_dwordx4 v[124:127], v1, s[20:23], s62 offen offset:1024 sc1
    s_mov_b32 s66, 1.0
    s_mov_b32 s67, 0x3f80
    s_mov_b32 s62, s63
    ds_read_b64_tr_b16 v[52:53], v2 offset:53248
    ds_read_b64_tr_b16 v[54:55], v2 offset:53760
    s_waitcnt lgkmcnt(6)
    v_mfma_f32_32x32x16_bf16 v[56:71], v[40:43], v[192:195], v[56:71]
    ds_read_b64_tr_b16 v[40:41], v2 offset:55296
    ds_read_b64_tr_b16 v[42:43], v2 offset:55808
    s_waitcnt lgkmcnt(6)
    v_mfma_f32_32x32x16_bf16 v[56:71], v[44:47], v[196:199], v[56:71]
    s_add_u32 m0, s49, 143360
    s_add_u32 s61, s50, 143360
    buffer_load_dwordx4 v9, s[16:19], s47 offen lds
    s_mov_b32 m0, s61
    s_add_u32 s47, s47, 401408
    buffer_load_dwordx4 v9, s[16:19], s48 offen lds
    s_add_u32 s48, s48, 401408
    s_waitcnt vmcnt(12)
    s_barrier
    ds_read_b64_tr_b16 v[44:45], v3 offset:0
    ds_read_b64_tr_b16 v[46:47], v3 offset:512
    s_waitcnt lgkmcnt(6)
    v_mfma_f32_32x32x16_bf16 v[56:71], v[48:51], v[200:203], v[56:71]
    ds_read_b64_tr_b16 v[48:49], v3 offset:2048
    ds_read_b64_tr_b16 v[50:51], v3 offset:2560
    s_waitcnt lgkmcnt(6)
    v_mfma_f32_32x32x16_bf16 v[56:71], v[52:55], v[204:207], v[56:71]
    ds_read_b64_tr_b16 v[52:53], v3 offset:4096
    ds_read_b64_tr_b16 v[54:55], v3 offset:4608
    s_waitcnt lgkmcnt(6)
    v_mfma_f32_32x32x16_bf16 v[56:71], v[40:43], v[208:211], v[56:71]
    ds_read_b64_tr_b16 v[40:41], v3 offset:6144
    ds_read_b64_tr_b16 v[42:43], v3 offset:6656
    s_waitcnt lgkmcnt(6)
    v_mfma_f32_32x32x16_bf16 v[56:71], v[44:47], v[212:215], v[56:71]
    s_add_u32 m0, s49, 0
    s_add_u32 s61, s50, 0
    buffer_load_dwordx4 v9, s[16:19], s47 offen lds
    s_mov_b32 m0, s61
    s_add_u32 s47, s47, 401408
    buffer_load_dwordx4 v9, s[16:19], s48 offen lds
    s_add_u32 s48, s48, 401408
    ds_read_b64_tr_b16 v[44:45], v3 offset:8192
    ds_read_b64_tr_b16 v[46:47], v3 offset:8704
    s_waitcnt lgkmcnt(6)
    v_mfma_f32_32x32x16_bf16 v[56:71], v[48:51], v[216:219], v[56:71]
    ds_read_b64_tr_b16 v[48:49], v3 offset:10240
    ds_read_b64_tr_b16 v[50:51], v3 offset:10752
    s_waitcnt lgkmcnt(6)
    v_mfma_f32_32x32x16_bf16 v[56:71], v[52:55], v[220:223], v[56:71]
    ds_read_b64_tr_b16 v[52:53], v3 offset:12288
    ds_read_b64_tr_b16 v[54:55], v3 offset:12800
    s_waitcnt lgkmcnt(6)
    v_mfma_f32_32x32x16_bf16 v[56:71], v[40:43], v[224:227], v[56:71]
    ds_read_b64_tr_b16 v[40:41], v6 offset:14336
    ds_read_b64_tr_b16 v[42:43], v6 offset:14848
    s_waitcnt lgkmcnt(6)
    v_mfma_f32_32x32x16_bf16 v[56:71], v[44:47], v[228:231], v[56:71]
    ds_read_b64_tr_b16 v[44:45], v6 offset:16384
    ds_read_b64_tr_b16 v[46:47], v6 offset:16896
    s_waitcnt lgkmcnt(6)
    v_mfma_f32_32x32x16_bf16 v[56:71], v[48:51], v[232:235], v[56:71]
    ds_read_b64_tr_b16 v[48:49], v6 offset:18432
    ds_read_b64_tr_b16 v[50:51], v6 offset:18944
    s_waitcnt lgkmcnt(6)
    v_mfma_f32_32x32x16_bf16 v[88:103], v[52:55], v[236:239], v[56:71]
    s_waitcnt vmcnt(6)
    s_barrier
    ds_read_b64_tr_b16 v[52:53], v6 offset:20480
    ds_read_b64_tr_b16 v[54:55], v6 offset:20992
    s_waitcnt lgkmcnt(6)
    v_mfma_f32_32x32x16_bf16 v[56:71], v[40:43], v[128:131], 0
    s_add_u32 m0, s49, 14336
    s_add_u32 s61, s50, 14336
    buffer_load_dwordx4 v9, s[16:19], s47 offen lds
    s_mov_b32 m0, s61
    s_add_u32 s47, s47, 401408
    buffer_load_dwordx4 v9, s[16:19], s48 offen lds
    s_add_u32 s48, s48, 401408
    ds_read_b64_tr_b16 v[40:41], v6 offset:22528
    ds_read_b64_tr_b16 v[42:43], v6 offset:23040
    s_waitcnt lgkmcnt(6)
    v_mfma_f32_32x32x16_bf16 v[56:71], v[44:47], v[132:135], v[56:71]
    v_mul_f32 v104, s66, v88
    v_mul_f32 v105, s66, v89
    ds_read_b64_tr_b16 v[44:45], v6 offset:24576
    ds_read_b64_tr_b16 v[46:47], v6 offset:25088
    s_waitcnt lgkmcnt(6)
    v_mfma_f32_32x32x16_bf16 v[56:71], v[48:51], v[136:139], v[56:71]
    v_mul_f32 v106, s66, v90
    v_mul_f32 v107, s66, v91
    ds_read_b64_tr_b16 v[48:49], v6 offset:26624
    ds_read_b64_tr_b16 v[50:51], v6 offset:27136
    s_waitcnt lgkmcnt(6)
    v_mfma_f32_32x32x16_bf16 v[56:71], v[52:55], v[140:143], v[56:71]
    v_mul_f32 v108, s66, v92
    v_mul_f32 v109, s66, v93
    ds_read_b64_tr_b16 v[52:53], v6 offset:28672
    ds_read_b64_tr_b16 v[54:55], v6 offset:29184
    s_waitcnt lgkmcnt(6)
    v_mfma_f32_32x32x16_bf16 v[56:71], v[40:43], v[144:147], v[56:71]
    v_mul_f32 v110, s66, v94
    v_mul_f32 v111, s66, v95
    ds_read_b64_tr_b16 v[40:41], v6 offset:30720
    ds_read_b64_tr_b16 v[42:43], v6 offset:31232
    s_waitcnt lgkmcnt(6)
    v_mfma_f32_32x32x16_bf16 v[56:71], v[44:47], v[148:151], v[56:71]
    v_mul_f32 v112, s66, v96
    v_mul_f32 v113, s66, v97
    ds_read_b64_tr_b16 v[44:45], v6 offset:32768
    ds_read_b64_tr_b16 v[46:47], v6 offset:33280
    s_waitcnt lgkmcnt(6)
    v_mfma_f32_32x32x16_bf16 v[56:71], v[48:51], v[152:155], v[56:71]
    v_mul_f32 v114, s66, v98
    v_mul_f32 v115, s66, v99
    ds_read_b64_tr_b16 v[48:49], v6 offset:34816
    ds_read_b64_tr_b16 v[50:51], v6 offset:35328
    s_waitcnt lgkmcnt(6)
    v_mfma_f32_32x32x16_bf16 v[56:71], v[52:55], v[156:159], v[56:71]
    s_add_u32 s47, s44, s53
    s_add_u32 s48, s47, s52
    s_add_u32 m0, s6, 28672
    s_add_u32 s61, s7, 28672
    buffer_load_dwordx4 v39, s[24:27], s47 offen lds
    s_mov_b32 m0, s61
    s_add_u32 s47, s47, 401408
    buffer_load_dwordx4 v39, s[24:27], s48 offen lds
    s_add_u32 s48, s48, 401408
    v_mul_f32 v116, s66, v100
    v_mul_f32 v117, s66, v101
    ds_read_b64_tr_b16 v[52:53], v6 offset:36864
    ds_read_b64_tr_b16 v[54:55], v6 offset:37376
    s_waitcnt lgkmcnt(6)
    v_mfma_f32_32x32x16_bf16 v[56:71], v[40:43], v[160:163], v[56:71]
    v_mul_f32 v118, s66, v102
    v_mul_f32 v119, s66, v103
    ds_read_b64_tr_b16 v[40:41], v6 offset:38912
    ds_read_b64_tr_b16 v[42:43], v6 offset:39424
    s_waitcnt lgkmcnt(6)
    v_mfma_f32_32x32x16_bf16 v[56:71], v[44:47], v[164:167], v[56:71]
    v_cvt_pk_bf16_f32 v120, v104, v105
    v_cvt_pk_bf16_f32 v121, v106, v107
    ds_read_b64_tr_b16 v[44:45], v6 offset:40960
    ds_read_b64_tr_b16 v[46:47], v6 offset:41472
    s_waitcnt lgkmcnt(6)
    v_mfma_f32_32x32x16_bf16 v[56:71], v[48:51], v[168:171], v[56:71]
    v_cvt_pk_bf16_f32 v122, v108, v109
    v_cvt_pk_bf16_f32 v123, v110, v111
    ds_read_b64_tr_b16 v[48:49], v6 offset:43008
    ds_read_b64_tr_b16 v[50:51], v6 offset:43520
    s_waitcnt lgkmcnt(6)
    v_mfma_f32_32x32x16_bf16 v[56:71], v[52:55], v[172:175], v[56:71]
    v_cvt_pk_bf16_f32 v124, v112, v113
    v_cvt_pk_bf16_f32 v125, v114, v115
    ds_read_b64_tr_b16 v[52:53], v6 offset:45056
    ds_read_b64_tr_b16 v[54:55], v6 offset:45568
    s_waitcnt lgkmcnt(6)
    v_mfma_f32_32x32x16_bf16 v[56:71], v[40:43], v[176:179], v[56:71]
    v_cvt_pk_bf16_f32 v126, v116, v117
    v_cvt_pk_bf16_f32 v127, v118, v119
    ds_read_b64_tr_b16 v[40:41], v6 offset:47104
    ds_read_b64_tr_b16 v[42:43], v6 offset:47616
    s_waitcnt lgkmcnt(6)
    v_mfma_f32_32x32x16_bf16 v[56:71], v[44:47], v[180:183], v[56:71]
    v_mov_b32 v104, s67
    v_mov_b32 v105, 0
    ds_read_b64_tr_b16 v[44:45], v6 offset:49152
    ds_read_b64_tr_b16 v[46:47], v6 offset:49664
    s_waitcnt lgkmcnt(6)
    v_mfma_f32_32x32x16_bf16 v[56:71], v[48:51], v[184:187], v[56:71]
    s_add_u32 m0, s6, 43008
    s_add_u32 s61, s7, 43008
    buffer_load_dwordx4 v39, s[24:27], s47 offen lds
    s_mov_b32 m0, s61
    s_add_u32 s47, s47, 401408
    buffer_load_dwordx4 v39, s[24:27], s48 offen lds
    s_add_u32 s48, s48, 401408
    v_cndmask_b32 v126, v126, v104, s[54:55]
    v_cndmask_b32 v127, v127, v105, s[54:55]
    ds_read_b64_tr_b16 v[48:49], v6 offset:51200
    ds_read_b64_tr_b16 v[50:51], v6 offset:51712
    s_waitcnt lgkmcnt(6)
    v_mfma_f32_32x32x16_bf16 v[56:71], v[52:55], v[188:191], v[56:71]
    buffer_store_dwordx4 v[120:123], v1, s[20:23], s62 offen sc1
    buffer_store_dwordx4 v[124:127], v1, s[20:23], s62 offen offset:1024 sc1
    s_mov_b32 s66, 1.0
    s_mov_b32 s67, 0x3f80
    s_mov_b32 s62, s63
    ds_read_b64_tr_b16 v[52:53], v6 offset:53248
    ds_read_b64_tr_b16 v[54:55], v6 offset:53760
    s_waitcnt lgkmcnt(6)
    v_mfma_f32_32x32x16_bf16 v[56:71], v[40:43], v[192:195], v[56:71]
    ds_read_b64_tr_b16 v[40:41], v6 offset:55296
    ds_read_b64_tr_b16 v[42:43], v6 offset:55808
    s_waitcnt lgkmcnt(6)
    v_mfma_f32_32x32x16_bf16 v[56:71], v[44:47], v[196:199], v[56:71]
    ds_read_b64_tr_b16 v[44:45], v7 offset:0
    ds_read_b64_tr_b16 v[46:47], v7 offset:512
    s_waitcnt lgkmcnt(6)
    v_mfma_f32_32x32x16_bf16 v[56:71], v[48:51], v[200:203], v[56:71]
    ds_read_b64_tr_b16 v[48:49], v7 offset:2048
    ds_read_b64_tr_b16 v[50:51], v7 offset:2560
    s_waitcnt lgkmcnt(6)
    v_mfma_f32_32x32x16_bf16 v[56:71], v[52:55], v[204:207], v[56:71]
    ds_read_b64_tr_b16 v[52:53], v7 offset:4096
    ds_read_b64_tr_b16 v[54:55], v7 offset:4608
    s_waitcnt lgkmcnt(6)
    v_mfma_f32_32x32x16_bf16 v[56:71], v[40:43], v[208:211], v[56:71]
    ds_read_b64_tr_b16 v[40:41], v7 offset:6144
    ds_read_b64_tr_b16 v[42:43], v7 offset:6656
    s_waitcnt lgkmcnt(6)
    v_mfma_f32_32x32x16_bf16 v[56:71], v[44:47], v[212:215], v[56:71]
    s_add_u32 m0, s6, 57344
    s_add_u32 s61, s7, 57344
    buffer_load_dwordx4 v39, s[24:27], s47 offen lds
    s_mov_b32 m0, s61
    s_add_u32 s47, s47, 401408
    buffer_load_dwordx4 v39, s[24:27], s48 offen lds
    s_add_u32 s48, s48, 401408
    ds_read_b64_tr_b16 v[44:45], v7 offset:8192
    ds_read_b64_tr_b16 v[46:47], v7 offset:8704
    s_waitcnt lgkmcnt(6)
    v_mfma_f32_32x32x16_bf16 v[56:71], v[48:51], v[216:219], v[56:71]
    ds_read_b64_tr_b16 v[48:49], v7 offset:10240
    ds_read_b64_tr_b16 v[50:51], v7 offset:10752
    s_waitcnt lgkmcnt(6)
    v_mfma_f32_32x32x16_bf16 v[56:71], v[52:55], v[220:223], v[56:71]
    ds_read_b64_tr_b16 v[52:53], v7 offset:12288
    ds_read_b64_tr_b16 v[54:55], v7 offset:12800
    s_waitcnt lgkmcnt(6)
    v_mfma_f32_32x32x16_bf16 v[56:71], v[40:43], v[224:227], v[56:71]
    ds_read_b64_tr_b16 v[40:41], v7 offset:14336
    ds_read_b64_tr_b16 v[42:43], v7 offset:14848
    s_waitcnt lgkmcnt(6)
    v_mfma_f32_32x32x16_bf16 v[56:71], v[44:47], v[228:231], v[56:71]
    ds_read_b64_tr_b16 v[44:45], v7 offset:16384
    ds_read_b64_tr_b16 v[46:47], v7 offset:16896
    s_waitcnt lgkmcnt(6)
    v_mfma_f32_32x32x16_bf16 v[56:71], v[48:51], v[232:235], v[56:71]
    ds_read_b64_tr_b16 v[48:49], v7 offset:18432
    ds_read_b64_tr_b16 v[50:51], v7 offset:18944
    s_waitcnt lgkmcnt(6)
    v_mfma_f32_32x32x16_bf16 v[72:87], v[52:55], v[236:239], v[56:71]
    s_waitcnt vmcnt(6)
    s_barrier
    ds_read_b64_tr_b16 v[52:53], v7 offset:20480
    ds_read_b64_tr_b16 v[54:55], v7 offset:20992
    s_waitcnt lgkmcnt(6)
    v_mfma_f32_32x32x16_bf16 v[56:71], v[40:43], v[128:131], 0
    s_add_u32 m0, s6, 71680
    s_add_u32 s61, s7, 71680
    buffer_load_dwordx4 v39, s[24:27], s47 offen lds
    s_mov_b32 m0, s61
    s_add_u32 s47, s47, 401408
    buffer_load_dwordx4 v39, s[24:27], s48 offen lds
    s_add_u32 s48, s48, 401408
    ds_read_b64_tr_b16 v[40:41], v7 offset:22528
    ds_read_b64_tr_b16 v[42:43], v7 offset:23040
    s_waitcnt lgkmcnt(6)
    v_mfma_f32_32x32x16_bf16 v[56:71], v[44:47], v[132:135], v[56:71]
    ds_read_b64_tr_b16 v[44:45], v7 offset:24576
    ds_read_b64_tr_b16 v[46:47], v7 offset:25088
    s_waitcnt lgkmcnt(6)
    v_mfma_f32_32x32x16_bf16 v[56:71], v[48:51], v[136:139], v[56:71]
    ds_read_b64_tr_b16 v[48:49], v7 offset:26624
    ds_read_b64_tr_b16 v[50:51], v7 offset:27136
    s_waitcnt lgkmcnt(6)
    v_mfma_f32_32x32x16_bf16 v[56:71], v[52:55], v[140:143], v[56:71]
    v_and_b32 v240, 63, v0
    s_and_b32 s36, s30, 1
    s_lshr_b32 s37, s30, 1
    ds_read_b64_tr_b16 v[52:53], v7 offset:28672
    ds_read_b64_tr_b16 v[54:55], v7 offset:29184
    s_waitcnt lgkmcnt(6)
    v_mfma_f32_32x32x16_bf16 v[56:71], v[40:43], v[144:147], v[56:71]
    s_and_b32 s31, s2, 15
    s_lshr_b32 s32, s2, 4
    s_lshr_b32 s58, s2, 3
    s_mul_i32 s59, s58, 37
    s_lshr_b32 s59, s59, 8
    s_mul_i32 s60, s59, 7
    s_sub_u32 s34, s58, s60
    ds_read_b64_tr_b16 v[40:41], v7 offset:30720
    ds_read_b64_tr_b16 v[42:43], v7 offset:31232
    s_waitcnt lgkmcnt(6)
    v_mfma_f32_32x32x16_bf16 v[56:71], v[44:47], v[148:151], v[56:71]
    s_and_b32 s33, s2, 7
    s_lshl_b32 s33, s33, 2
    s_add_u32 s33, s33, s59
    s_cmp_lt_u32 s2, 224
    s_cselect_b32 s35, 1, 0
    ds_read_b64_tr_b16 v[44:45], v7 offset:32768
    ds_read_b64_tr_b16 v[46:47], v7 offset:33280
    s_waitcnt lgkmcnt(6)
    v_mfma_f32_32x32x16_bf16 v[56:71], v[48:51], v[152:155], v[56:71]
    s_and_b32 s59, s31, 14
    s_mov_b32 s61, s59
    s_add_u32 s60, s59, 1
    v_and_b32 v241, 15, v240
    v_lshlrev_b32 v241, 4, v241
    v_add_u32 v242, s61, v241
    v_add_u32 v243, s60, v241
    v_cmp_gt_u32 vcc, 16, v240
    s_nop 1
    v_cndmask_b32 v242, v243, v242, vcc
    s_lshl_b32 s58, s32, 4
    s_add_u32 s58, s58, s59
    v_mov_b32 v243, s58
    v_cmp_gt_u32 vcc, 32, v240
    s_nop 1
    v_cndmask_b32 v242, v243, v242, vcc
    v_lshlrev_b32 v252, 2, v242
    s_mov_b32 s47, 16782336
    ds_read_b64_tr_b16 v[48:49], v7 offset:34816
    ds_read_b64_tr_b16 v[50:51], v7 offset:35328
    s_waitcnt lgkmcnt(6)
    v_mfma_f32_32x32x16_bf16 v[56:71], v[52:55], v[156:159], v[56:71]
    s_lshl_b32 s40, s31, 18
    s_lshl_b32 s41, s30, 11
    s_add_u32 s40, s40, s41
    s_add_u32 s40, s40, 2097152
    ds_read_b64_tr_b16 v[52:53], v7 offset:36864
    ds_read_b64_tr_b16 v[54:55], v7 offset:37376
    s_waitcnt lgkmcnt(6)
    v_mfma_f32_32x32x16_bf16 v[56:71], v[40:43], v[160:163], v[56:71]
    s_lshl_b32 s59, s32, 2
    s_lshl_b32 s60, s36, 1
    s_add_u32 s59, s59, s60
    s_lshr_b32 s60, s37, 1
    s_add_u32 s59, s59, s60
    s_lshl_b32 s48, s59, 5
    s_lshl_b32 s60, s31, 1
    s_add_u32 s48, s48, s60
    s_and_b32 s60, s37, 1
    s_add_u32 s48, s48, s60
    s_lshl_b32 s48, s48, 10
    s_add_u32 s48, s48, 14680064
    ds_read_b64_tr_b16 v[40:41], v7 offset:38912
    ds_read_b64_tr_b16 v[42:43], v7 offset:39424
    s_waitcnt lgkmcnt(6)
    v_mfma_f32_32x32x16_bf16 v[56:71], v[44:47], v[164:167], v[56:71]
    s_mov_b32 s8, s28
    s_mov_b32 s9, s29
    s_mov_b32 s10, 1605632
    s_mov_b32 s11, 0x20000
    ds_read_b64_tr_b16 v[44:45], v7 offset:40960
    ds_read_b64_tr_b16 v[46:47], v7 offset:41472
    s_waitcnt lgkmcnt(6)
    v_mfma_f32_32x32x16_bf16 v[56:71], v[48:51], v[168:171], v[56:71]
    s_waitcnt vmcnt(4)
    s_barrier
    s_cmp_eq_u32 s30, 0
    s_cbranch_scc0 parallel_sum__softmax_full_mha__swiglu_ffn__prompt_kernel_fs2
    s_lshl_b32 s58, s75, 2
    s_add_u32 s58, s58, 16782336
    v_mov_b32 v26, s3
    v_mov_b32 v27, 0
    buffer_store_dword v26, v27, s[20:23], s58 offen sc1
parallel_sum__softmax_full_mha__swiglu_ffn__prompt_kernel_fs2:
    s_waitcnt lgkmcnt(0)
    s_mov_b32 s12, s4
    s_mov_b32 s13, s5
    s_mov_b32 s14, 401408
    s_mov_b32 s15, 0x20000
    ds_read_b64_tr_b16 v[48:49], v5 offset:0
    ds_read_b64_tr_b16 v[50:51], v5 offset:512
    v_mfma_f32_32x32x16_bf16 v[56:71], v[52:55], v[172:175], v[56:71]
    s_mov_b32 s16, s38
    s_mov_b32 s17, s39
    s_mov_b32 s18, 1835008
    s_mov_b32 s19, 0x20000
    ds_read_b64_tr_b16 v[52:53], v5 offset:2048
    ds_read_b64_tr_b16 v[54:55], v5 offset:2560
    v_mfma_f32_32x32x16_bf16 v[56:71], v[40:43], v[176:179], v[56:71]
    s_lshl_b32 s58, s37, 12
    v_add_u32 v2, s58, v1
    v_and_b32 v244, 31, v0
    v_bfe_u32 v245, v0, 5, 1
    ds_read_b64_tr_b16 v[40:41], v5 offset:4096
    ds_read_b64_tr_b16 v[42:43], v5 offset:4608
    v_mfma_f32_32x32x16_bf16 v[56:71], v[44:47], v[180:183], v[56:71]
    v_lshrrev_b32 v246, 3, v240
    v_mul_u32_u24 v246, 896, v246
    v_bfe_u32 v247, v240, 4, 1
    v_lshlrev_b32 v247, 2, v247
    v_and_b32 v248, 7, v240
    v_xor_b32 v247, v247, v248
    ds_read_b64_tr_b16 v[44:45], v5 offset:6144
    ds_read_b64_tr_b16 v[46:47], v5 offset:6656
    s_waitcnt lgkmcnt(6)
    v_mfma_f32_32x32x16_bf16 v[56:71], v[48:51], v[184:187], v[56:71]
    v_lshlrev_b32 v247, 4, v247
    v_add_u32 v16, v246, v247
    ds_read_b64_tr_b16 v[48:49], v5 offset:8192
    ds_read_b64_tr_b16 v[50:51], v5 offset:8704
    s_waitcnt lgkmcnt(6)
    v_mfma_f32_32x32x16_bf16 v[56:71], v[52:55], v[188:191], v[56:71]
    s_cmp_lt_u32 s30, 4
    s_cbranch_scc0 parallel_sum__softmax_full_mha__swiglu_ffn__prompt_kernel_by_setB
    v_mov_b32 v12, v1
    v_mov_b32 v13, v1
    v_mov_b32 v14, v1
    v_mov_b32 v15, v1
    s_lshr_b32 s60, s30, 1
    s_lshl_b32 s58, s33, 1
    s_add_u32 s58, s58, s60
    s_mul_i32 s42, s58, 114688
    s_and_b32 s61, s30, 1
    s_lshl_b32 s61, s61, 12
    s_add_u32 s42, s42, s61
    s_add_u32 s42, s42, 6291456
    s_mov_b32 s44, 8192
    s_lshl_b32 s43, s60, 13
    s_add_u32 s43, s43, s61
    s_mov_b64 s[76:77], s[20:21]
    s_mov_b32 s78, 20971520
    s_branch parallel_sum__softmax_full_mha__swiglu_ffn__prompt_kernel_by_setC
parallel_sum__softmax_full_mha__swiglu_ffn__prompt_kernel_by_setB:
    v_add_u32 v12, 0, v16
    v_add_u32 v13, 6144, v16
    v_add_u32 v14, 12288, v16
    v_add_u32 v15, 18432, v16
    s_sub_u32 s58, s30, 4
    s_mul_i32 s42, s58, 28672
    s_lshl_b32 s59, s34, 7
    s_add_u32 s42, s42, s59
    s_mov_b32 s44, 114688
    s_lshl_b32 s43, s58, 12
    s_add_u32 s43, s43, 16384
    s_mov_b64 s[76:77], s[8:9]
    s_mov_b32 s78, 1605632
parallel_sum__softmax_full_mha__swiglu_ffn__prompt_kernel_by_setC:
    s_mov_b32 s79, 0x20000
    s_add_u32 s43, s43, 49152
    ds_read_b64_tr_b16 v[52:53], v5 offset:10240
    ds_read_b64_tr_b16 v[54:55], v5 offset:10752
    s_waitcnt lgkmcnt(6)
    v_mfma_f32_32x32x16_bf16 v[56:71], v[40:43], v[192:195], v[56:71]
    s_lshl_b32 s58, s33, 6
    s_lshr_b32 s59, s37, 1
    s_lshl_b32 s59, s59, 5
    s_add_u32 s58, s58, s59
    s_mul_i32 s58, s58, 896
    s_lshl_b32 s59, s34, 7
    s_lshl_b32 s60, s36, 6
    s_add_u32 s58, s58, s59
    s_add_u32 s46, s58, s60
    s_and_b32 s58, s37, 1
    s_lshl_b32 s58, s58, 5
    s_add_u32 s46, s46, s58
    ds_read_b64_tr_b16 v[40:41], v5 offset:12288
    ds_read_b64_tr_b16 v[42:43], v5 offset:12800
    s_waitcnt lgkmcnt(6)
    v_mfma_f32_32x32x16_bf16 v[56:71], v[44:47], v[196:199], v[56:71]
    v_mul_u32_u24 v18, 896, v244
    v_lshlrev_b32 v246, 4, v245
    v_add_u32 v18, v18, v246
    ds_read_b64_tr_b16 v[44:45], v5 offset:14336
    ds_read_b64_tr_b16 v[46:47], v5 offset:14848
    s_waitcnt lgkmcnt(6)
    v_mfma_f32_32x32x16_bf16 v[56:71], v[48:51], v[200:203], v[56:71]
    v_bfe_u32 v246, v240, 2, 2
    v_lshlrev_b32 v247, 2, v245
    v_add_u32 v247, v247, v246
    v_lshlrev_b32 v17, 7, v247
    ds_read_b64_tr_b16 v[48:49], v5 offset:16384
    ds_read_b64_tr_b16 v[50:51], v5 offset:16896
    s_waitcnt lgkmcnt(6)
    v_mfma_f32_32x32x16_bf16 v[56:71], v[52:55], v[204:207], v[56:71]
    v_lshrrev_b32 v246, 1, v246
    v_xor_b32 v246, s36, v246
    v_lshlrev_b32 v246, 6, v246
    v_add_u32 v17, v17, v246
    ds_read_b64_tr_b16 v[52:53], v5 offset:18432
    ds_read_b64_tr_b16 v[54:55], v5 offset:18944
    s_waitcnt lgkmcnt(6)
    v_mfma_f32_32x32x16_bf16 v[56:71], v[40:43], v[208:211], v[56:71]
    v_bfe_u32 v246, v240, 4, 1
    v_lshlrev_b32 v246, 5, v246
    v_add_u32 v17, v17, v246
    ds_read_b64_tr_b16 v[40:41], v5 offset:20480
    ds_read_b64_tr_b16 v[42:43], v5 offset:20992
    s_waitcnt lgkmcnt(6)
    v_mfma_f32_32x32x16_bf16 v[56:71], v[44:47], v[212:215], v[56:71]
    v_and_b32 v246, 3, v240
    v_lshlrev_b32 v246, 3, v246
    v_add_u32 v17, v17, v246
    ds_read_b64_tr_b16 v[44:45], v5 offset:22528
    ds_read_b64_tr_b16 v[46:47], v5 offset:23040
    s_waitcnt lgkmcnt(6)
    v_mfma_f32_32x32x16_bf16 v[56:71], v[48:51], v[216:219], v[56:71]
    s_lshl_b32 s58, s37, 11
    s_add_u32 s58, s58, 49152
    v_add_u32 v3, s58, v1
    s_lshl_b32 s59, s37, 12
    s_add_u32 s59, s59, 65536
    v_add_u32 v9, s59, v17
    ds_read_b64_tr_b16 v[48:49], v5 offset:24576
    ds_read_b64_tr_b16 v[50:51], v5 offset:25088
    s_waitcnt lgkmcnt(6)
    v_mfma_f32_32x32x16_bf16 v[56:71], v[52:55], v[220:223], v[56:71]
    s_lshl_b32 s58, s37, 11
    s_add_u32 s58, s58, 81920
    v_add_u32 v4, s58, v1
    s_lshl_b32 s59, s37, 12
    s_add_u32 s59, s59, 98304
    v_add_u32 v10, s59, v17
    ds_read_b64_tr_b16 v[52:53], v5 offset:26624
    ds_read_b64_tr_b16 v[54:55], v5 offset:27136
    s_waitcnt lgkmcnt(6)
    v_mfma_f32_32x32x16_bf16 v[56:71], v[40:43], v[224:227], v[56:71]
    s_lshl_b32 s58, s37, 11
    s_add_u32 s58, s58, 114688
    v_add_u32 v8, s58, v1
    s_lshl_b32 s59, s37, 12
    s_add_u32 s59, s59, 131072
    v_add_u32 v11, s59, v17
    ds_read_b64_tr_b16 v[40:41], v36 offset:28672
    ds_read_b64_tr_b16 v[42:43], v36 offset:28928
    s_waitcnt lgkmcnt(6)
    v_mfma_f32_32x32x16_bf16 v[56:71], v[44:47], v[228:231], v[56:71]
    s_lshl_b32 s50, s34, 7
    s_mul_i32 s58, s30, 7168
    s_add_u32 s50, s50, s58
    s_lshl_b32 s51, s30, 10
    s_lshl_b32 s58, s31, 6
    s_lshl_b32 s59, s32, 2
    s_add_u32 s58, s58, s59
    s_lshl_b32 s58, s58, 11
    s_lshl_b32 s59, s30, 10
    s_add_u32 s58, s58, s59
    s_add_u32 s53, s58, 0
    ds_read_b64_tr_b16 v[44:45], v36 offset:29696
    ds_read_b64_tr_b16 v[46:47], v36 offset:29952
    s_waitcnt lgkmcnt(6)
    v_mfma_f32_32x32x16_bf16 v[56:71], v[48:51], v[232:235], v[56:71]
    ds_read_b64_tr_b16 v[48:49], v36 offset:30720
    ds_read_b64_tr_b16 v[50:51], v36 offset:30976
    s_waitcnt lgkmcnt(6)
    v_mfma_f32_32x32x16_bf16 v[88:103], v[52:55], v[236:239], v[56:71]
    s_waitcnt vmcnt(0)
    s_barrier
    ds_read_b64_tr_b16 v[52:53], v36 offset:31744
    ds_read_b64_tr_b16 v[54:55], v36 offset:32000
    s_waitcnt lgkmcnt(6)
    v_mfma_f32_32x32x16_bf16 v[56:71], v[40:43], v[128:131], 0
    ds_read_b64_tr_b16 v[40:41], v36 offset:32768
    ds_read_b64_tr_b16 v[42:43], v36 offset:33024
    s_waitcnt lgkmcnt(6)
    v_mfma_f32_32x32x16_bf16 v[56:71], v[44:47], v[132:135], v[56:71]
    v_mul_f32 v104, 0xbfb8aa3b, v72
    v_mul_f32 v105, 0xbfb8aa3b, v73
    v_mul_f32 v106, 0xbfb8aa3b, v74
    v_mul_f32 v107, 0xbfb8aa3b, v75
    ds_read_b64_tr_b16 v[44:45], v36 offset:33792
    ds_read_b64_tr_b16 v[46:47], v36 offset:34048
    s_waitcnt lgkmcnt(6)
    v_mfma_f32_32x32x16_bf16 v[56:71], v[48:51], v[136:139], v[56:71]
    v_exp_f32 v104, v104
    v_mul_f32 v108, v72, v88
    v_exp_f32 v105, v105
    v_mul_f32 v109, v73, v89
    v_exp_f32 v106, v106
    ds_read_b64_tr_b16 v[48:49], v36 offset:34816
    ds_read_b64_tr_b16 v[50:51], v36 offset:35072
    s_waitcnt lgkmcnt(6)
    v_mfma_f32_32x32x16_bf16 v[56:71], v[52:55], v[140:143], v[56:71]
    v_mul_f32 v110, v74, v90
    v_exp_f32 v107, v107
    v_mul_f32 v111, v75, v91
    v_add_f32 v104, 1.0, v104
    ds_read_b64_tr_b16 v[52:53], v36 offset:43008
    ds_read_b64_tr_b16 v[54:55], v36 offset:43264
    s_waitcnt lgkmcnt(6)
    v_mfma_f32_32x32x16_bf16 v[56:71], v[40:43], v[144:147], v[56:71]
    v_add_f32 v105, 1.0, v105
    v_add_f32 v106, 1.0, v106
    v_add_f32 v107, 1.0, v107
    v_rcp_f32 v104, v104
    ds_read_b64_tr_b16 v[40:41], v36 offset:44032
    ds_read_b64_tr_b16 v[42:43], v36 offset:44288
    s_waitcnt lgkmcnt(6)
    v_mfma_f32_32x32x16_bf16 v[56:71], v[44:47], v[148:151], v[56:71]
    v_rcp_f32 v105, v105
    v_rcp_f32 v106, v106
    v_rcp_f32 v107, v107
    v_mul_f32 v108, v108, v104
    v_mul_f32 v109, v109, v105
    ds_read_b64_tr_b16 v[44:45], v36 offset:45056
    ds_read_b64_tr_b16 v[46:47], v36 offset:45312
    s_waitcnt lgkmcnt(6)
    v_mfma_f32_32x32x16_bf16 v[56:71], v[48:51], v[152:155], v[56:71]
    v_mul_f32 v110, v110, v106
    v_mul_f32 v111, v111, v107
    v_cvt_pk_bf16_f32 v112, v108, v109
    v_cvt_pk_bf16_f32 v113, v110, v111
    ds_read_b64_tr_b16 v[48:49], v36 offset:46080
    ds_read_b64_tr_b16 v[50:51], v36 offset:46336
    s_waitcnt lgkmcnt(6)
    v_mfma_f32_32x32x16_bf16 v[56:71], v[52:55], v[156:159], v[56:71]
    v_mul_f32 v104, 0xbfb8aa3b, v76
    v_mul_f32 v105, 0xbfb8aa3b, v77
    v_mul_f32 v106, 0xbfb8aa3b, v78
    v_mul_f32 v107, 0xbfb8aa3b, v79
    ds_read_b64_tr_b16 v[52:53], v36 offset:47104
    ds_read_b64_tr_b16 v[54:55], v36 offset:47360
    s_waitcnt lgkmcnt(6)
    v_mfma_f32_32x32x16_bf16 v[56:71], v[40:43], v[160:163], v[56:71]
    v_exp_f32 v104, v104
    v_mul_f32 v108, v76, v92
    v_exp_f32 v105, v105
    v_mul_f32 v109, v77, v93
    ds_read_b64_tr_b16 v[40:41], v36 offset:48128
    ds_read_b64_tr_b16 v[42:43], v36 offset:48384
    s_waitcnt lgkmcnt(6)
    v_mfma_f32_32x32x16_bf16 v[56:71], v[44:47], v[164:167], v[56:71]
    v_exp_f32 v106, v106
    v_mul_f32 v110, v78, v94
    v_exp_f32 v107, v107
    v_mul_f32 v111, v79, v95
    v_add_f32 v104, 1.0, v104
    ds_read_b64_tr_b16 v[44:45], v36 offset:49152
    ds_read_b64_tr_b16 v[46:47], v36 offset:49408
    s_waitcnt lgkmcnt(6)
    v_mfma_f32_32x32x16_bf16 v[56:71], v[48:51], v[168:171], v[56:71]
    v_add_f32 v105, 1.0, v105
    v_add_f32 v106, 1.0, v106
    v_add_f32 v107, 1.0, v107
    v_rcp_f32 v104, v104
    ds_read_b64_tr_b16 v[48:49], v37 offset:0
    ds_read_b64_tr_b16 v[50:51], v37 offset:256
    s_waitcnt lgkmcnt(6)
    v_mfma_f32_32x32x16_bf16 v[56:71], v[52:55], v[172:175], v[56:71]
    v_rcp_f32 v105, v105
    v_rcp_f32 v106, v106
    v_rcp_f32 v107, v107
    v_mul_f32 v108, v108, v104
    ds_read_b64_tr_b16 v[52:53], v37 offset:1024
    ds_read_b64_tr_b16 v[54:55], v37 offset:1280
    s_waitcnt lgkmcnt(6)
    v_mfma_f32_32x32x16_bf16 v[56:71], v[40:43], v[176:179], v[56:71]
    v_mul_f32 v109, v109, v105
    v_mul_f32 v110, v110, v106
    v_mul_f32 v111, v111, v107
    v_cvt_pk_bf16_f32 v114, v108, v109
    ds_read_b64_tr_b16 v[40:41], v37 offset:2048
    ds_read_b64_tr_b16 v[42:43], v37 offset:2304
    s_waitcnt lgkmcnt(6)
    v_mfma_f32_32x32x16_bf16 v[56:71], v[44:47], v[180:183], v[56:71]
    v_cvt_pk_bf16_f32 v115, v110, v111
    buffer_store_dwordx4 v[112:115], v1, s[20:23], s65 offen offset:0 sc1
    v_mul_f32 v104, 0xbfb8aa3b, v80
    v_mul_f32 v105, 0xbfb8aa3b, v81
    v_mul_f32 v106, 0xbfb8aa3b, v82
    ds_read_b64_tr_b16 v[44:45], v37 offset:3072
    ds_read_b64_tr_b16 v[46:47], v37 offset:3328
    s_waitcnt lgkmcnt(6)
    v_mfma_f32_32x32x16_bf16 v[56:71], v[48:51], v[184:187], v[56:71]
    v_mul_f32 v107, 0xbfb8aa3b, v83
    v_exp_f32 v104, v104
    v_mul_f32 v108, v80, v96
    v_exp_f32 v105, v105
    ds_read_b64_tr_b16 v[48:49], v37 offset:4096
    ds_read_b64_tr_b16 v[50:51], v37 offset:4352
    s_waitcnt lgkmcnt(6)
    v_mfma_f32_32x32x16_bf16 v[56:71], v[52:55], v[188:191], v[56:71]
    v_mul_f32 v109, v81, v97
    v_exp_f32 v106, v106
    v_mul_f32 v110, v82, v98
    v_exp_f32 v107, v107
    ds_read_b64_tr_b16 v[52:53], v37 offset:5120
    ds_read_b64_tr_b16 v[54:55], v37 offset:5376
    s_waitcnt lgkmcnt(6)
    v_mfma_f32_32x32x16_bf16 v[56:71], v[40:43], v[192:195], v[56:71]
    v_mul_f32 v111, v83, v99
    v_add_f32 v104, 1.0, v104
    v_add_f32 v105, 1.0, v105
    v_add_f32 v106, 1.0, v106
    v_add_f32 v107, 1.0, v107
    ds_read_b64_tr_b16 v[40:41], v37 offset:6144
    ds_read_b64_tr_b16 v[42:43], v37 offset:6400
    s_waitcnt lgkmcnt(6)
    v_mfma_f32_32x32x16_bf16 v[56:71], v[44:47], v[196:199], v[56:71]
    v_rcp_f32 v104, v104
    v_rcp_f32 v105, v105
    v_rcp_f32 v106, v106
    buffer_load_dword v253, v252, s[20:23], s47 offen sc1
    v_rcp_f32 v107, v107
    ds_read_b64_tr_b16 v[44:45], v37 offset:14336
    ds_read_b64_tr_b16 v[46:47], v37 offset:14592
    s_waitcnt lgkmcnt(6)
    v_mfma_f32_32x32x16_bf16 v[56:71], v[48:51], v[200:203], v[56:71]
    v_mul_f32 v108, v108, v104
    v_mul_f32 v109, v109, v105
    v_mul_f32 v110, v110, v106
    v_mul_f32 v111, v111, v107
    ds_read_b64_tr_b16 v[48:49], v37 offset:15360
    ds_read_b64_tr_b16 v[50:51], v37 offset:15616
    s_waitcnt lgkmcnt(6)
    v_mfma_f32_32x32x16_bf16 v[56:71], v[52:55], v[204:207], v[56:71]
    v_cvt_pk_bf16_f32 v116, v108, v109
    v_cvt_pk_bf16_f32 v117, v110, v111
    v_mul_f32 v104, 0xbfb8aa3b, v84
    v_mul_f32 v105, 0xbfb8aa3b, v85
    ds_read_b64_tr_b16 v[52:53], v37 offset:16384
    ds_read_b64_tr_b16 v[54:55], v37 offset:16640
    s_waitcnt lgkmcnt(6)
    v_mfma_f32_32x32x16_bf16 v[56:71], v[40:43], v[208:211], v[56:71]
    v_mul_f32 v106, 0xbfb8aa3b, v86
    v_mul_f32 v107, 0xbfb8aa3b, v87
    v_exp_f32 v104, v104
    v_mul_f32 v108, v84, v100
    v_exp_f32 v105, v105
    ds_read_b64_tr_b16 v[40:41], v37 offset:17408
    ds_read_b64_tr_b16 v[42:43], v37 offset:17664
    s_waitcnt lgkmcnt(6)
    v_mfma_f32_32x32x16_bf16 v[56:71], v[44:47], v[212:215], v[56:71]
    v_mul_f32 v109, v85, v101
    v_exp_f32 v106, v106
    v_mul_f32 v110, v86, v102
    v_exp_f32 v107, v107
    ds_read_b64_tr_b16 v[44:45], v37 offset:18432
    ds_read_b64_tr_b16 v[46:47], v37 offset:18688
    s_waitcnt lgkmcnt(6)
    v_mfma_f32_32x32x16_bf16 v[56:71], v[48:51], v[216:219], v[56:71]
    v_mul_f32 v111, v87, v103
    v_add_f32 v104, 1.0, v104
    v_add_f32 v105, 1.0, v105
    v_add_f32 v106, 1.0, v106
    ds_read_b64_tr_b16 v[48:49], v37 offset:19456
    ds_read_b64_tr_b16 v[50:51], v37 offset:19712
    s_waitcnt lgkmcnt(6)
    v_mfma_f32_32x32x16_bf16 v[56:71], v[52:55], v[220:223], v[56:71]
    v_add_f32 v107, 1.0, v107
    v_rcp_f32 v104, v104
    v_rcp_f32 v105, v105
    v_rcp_f32 v106, v106
    v_rcp_f32 v107, v107
    ds_read_b64_tr_b16 v[52:53], v37 offset:20480
    ds_read_b64_tr_b16 v[54:55], v37 offset:20736
    s_waitcnt lgkmcnt(6)
    v_mfma_f32_32x32x16_bf16 v[56:71], v[40:43], v[224:227], v[56:71]
    v_mul_f32 v108, v108, v104
    v_mul_f32 v109, v109, v105
    v_mul_f32 v110, v110, v106
    v_mul_f32 v111, v111, v107
    s_waitcnt lgkmcnt(4)
    v_mfma_f32_32x32x16_bf16 v[56:71], v[44:47], v[228:231], v[56:71]
    v_cvt_pk_bf16_f32 v118, v108, v109
    v_cvt_pk_bf16_f32 v119, v110, v111
    buffer_store_dwordx4 v[116:119], v1, s[20:23], s65 offen offset:1024 sc1
    s_add_u32 s65, s65, 4096
    s_waitcnt lgkmcnt(2)
    v_mfma_f32_32x32x16_bf16 v[56:71], v[48:51], v[232:235], v[56:71]
    s_waitcnt lgkmcnt(0)
    v_mfma_f32_32x32x16_bf16 v[72:87], v[52:55], v[236:239], v[56:71]
    s_barrier
    s_mov_b32 s49, 0x200000
parallel_sum__softmax_full_mha__swiglu_ffn__prompt_kernel_by_kvchk:
    s_waitcnt vmcnt(1)
    v_cmp_eq_u32 vcc, s3, v253
    s_nop 0
    s_cmp_eq_u64 vcc, -1
    s_cbranch_scc1 parallel_sum__softmax_full_mha__swiglu_ffn__prompt_kernel_by_kvok
    buffer_load_dword v253, v252, s[20:23], s47 offen sc1
    s_waitcnt vmcnt(0)
    s_sub_u32 s49, s49, 1
    s_cmp_lg_u32 s49, 0
    s_cbranch_scc1 parallel_sum__softmax_full_mha__swiglu_ffn__prompt_kernel_by_kvchk
parallel_sum__softmax_full_mha__swiglu_ffn__prompt_kernel_by_kvok:
    s_add_u32 m0, s41, 0
    s_add_u32 s45, s40, 0
    buffer_load_dwordx4 v1, s[20:23], s45 offen sc1 lds
    buffer_load_dwordx4 v1, s[20:23], s45 offen offset:1024 sc1 lds
    s_lshl_b32 s58, s30, 10
    s_add_u32 m0, s58, 49152
    s_nop 0
    buffer_load_dwordx4 v1, s[20:23], s53 offen sc1 lds
    s_nop 4
    v_mul_f32 v104, 0xbfb8aa3b, v72
    v_mul_f32 v105, 0xbfb8aa3b, v73
    v_mul_f32 v106, 0xbfb8aa3b, v74
    v_mul_f32 v107, 0xbfb8aa3b, v75
    v_exp_f32 v104, v104
    v_mul_f32 v108, v72, v80
    v_exp_f32 v105, v105
    v_mul_f32 v109, v73, v81
    v_exp_f32 v106, v106
    v_mul_f32 v110, v74, v82
    v_exp_f32 v107, v107
    v_mul_f32 v111, v75, v83
    v_add_f32 v104, 1.0, v104
    v_add_f32 v105, 1.0, v105
    v_add_f32 v106, 1.0, v106
    v_add_f32 v107, 1.0, v107
    v_rcp_f32 v104, v104
    v_rcp_f32 v105, v105
    v_rcp_f32 v106, v106
    v_rcp_f32 v107, v107
    v_mul_f32 v108, v108, v104
    v_mul_f32 v109, v109, v105
    v_mul_f32 v110, v110, v106
    v_mul_f32 v111, v111, v107
    v_cvt_pk_bf16_f32 v112, v108, v109
    v_cvt_pk_bf16_f32 v113, v110, v111
    v_mul_f32 v104, 0xbfb8aa3b, v76
    v_mul_f32 v105, 0xbfb8aa3b, v77
    v_mul_f32 v106, 0xbfb8aa3b, v78
    v_mul_f32 v107, 0xbfb8aa3b, v79
    v_exp_f32 v104, v104
    v_mul_f32 v108, v76, v84
    v_exp_f32 v105, v105
    v_mul_f32 v109, v77, v85
    v_exp_f32 v106, v106
    v_mul_f32 v110, v78, v86
    v_exp_f32 v107, v107
    v_mul_f32 v111, v79, v87
    v_add_f32 v104, 1.0, v104
    v_add_f32 v105, 1.0, v105
    v_add_f32 v106, 1.0, v106
    v_add_f32 v107, 1.0, v107
    v_rcp_f32 v104, v104
    v_rcp_f32 v105, v105
    v_rcp_f32 v106, v106
    v_rcp_f32 v107, v107
    v_mul_f32 v108, v108, v104
    v_mul_f32 v109, v109, v105
    v_mul_f32 v110, v110, v106
    v_mul_f32 v111, v111, v107
    v_cvt_pk_bf16_f32 v114, v108, v109
    v_cvt_pk_bf16_f32 v115, v110, v111
    buffer_store_dwordx4 v[112:115], v1, s[20:23], s71 offen sc1
parallel_sum__softmax_full_mha__swiglu_ffn__prompt_kernel_a_fin:
    s_add_u32 m0, s41, 16384
    s_add_u32 s45, s40, 16384
    buffer_load_dwordx4 v1, s[20:23], s45 offen sc1 lds
    buffer_load_dwordx4 v1, s[20:23], s45 offen offset:1024 sc1 lds
    s_waitcnt vmcnt(3)
    s_barrier
    s_lshl_b32 s58, s36, 12
    v_add_u32 v241, s58, v1
    ds_read_b128 v[20:23], v241 offset:49152
    ds_read_b128 v[24:27], v241 offset:50176
    ds_read_b128 v[28:31], v241 offset:51200
    ds_read_b128 v[32:35], v241 offset:52224
    ds_read_b128 v[212:215], v1
    ds_read_b128 v[216:219], v1 offset:1024
    ds_read_b128 v[36:39], v2 offset:0
    ds_read_b128 v[40:43], v2 offset:1024
    ds_read_b128 v[52:55], v2 offset:2048
    ds_read_b128 v[56:59], v2 offset:3072
    s_add_u32 m0, s41, 32768
    s_add_u32 s45, s40, 32768
    buffer_load_dwordx4 v1, s[20:23], s45 offen sc1 lds
    buffer_load_dwordx4 v1, s[20:23], s45 offen offset:1024 sc1 lds
    s_waitcnt lgkmcnt(5)
    v_mfma_f32_32x32x16_bf16 v[84:99], v[212:215], v[20:23], 0
    s_waitcnt lgkmcnt(4)
    v_mfma_f32_32x32x16_bf16 v[84:99], v[216:219], v[24:27], v[84:99]
    v_mfma_f32_32x32x16_bf16 v[116:131], v[212:215], v[28:31], 0
    v_mfma_f32_32x32x16_bf16 v[116:131], v[216:219], v[32:35], v[116:131]
    s_nop 9
    v_max3_f32 v240, v84, v85, v86
    v_max3_f32 v241, v87, v88, v89
    v_max3_f32 v242, v90, v91, v92
    v_max3_f32 v243, v93, v94, v95
    v_max3_f32 v240, v240, v96, v97
    v_max3_f32 v241, v241, v98, v99
    v_max3_f32 v240, v240, v241, v242
    v_max_f32 v240, v240, v243
    v_max3_f32 v244, v116, v117, v118
    v_max3_f32 v245, v119, v120, v121
    v_max3_f32 v246, v122, v123, v124
    v_max3_f32 v247, v125, v126, v127
    v_max3_f32 v244, v244, v128, v129
    v_max3_f32 v245, v245, v130, v131
    v_max3_f32 v244, v244, v245, v246
    v_max_f32 v244, v244, v247
    v_mov_b32 v241, v240
    s_nop 1
    v_permlane32_swap_b32 v240, v241
    v_max_f32 v240, v240, v241
    v_add_f32 v240, 0x42800000, v240
    v_sub_f32 v240, 0, v240
    v_mov_b32 v241, 0
    v_cvt_pk_bf16_f32 v240, v240, v241
    v_cndmask_b32 v26, v26, v240, s[54:55]
    v_mov_b32 v245, v244
    s_nop 1
    v_permlane32_swap_b32 v244, v245
    v_max_f32 v244, v244, v245
    v_add_f32 v244, 0x42800000, v244
    v_sub_f32 v244, 0, v244
    v_mov_b32 v245, 0
    v_cvt_pk_bf16_f32 v244, v244, v245
    v_cndmask_b32 v34, v34, v244, s[54:55]
    s_waitcnt lgkmcnt(3)
    v_mfma_f32_32x32x16_bf16 v[68:83], v[36:39], v[20:23], 0
    s_waitcnt lgkmcnt(2)
    v_mfma_f32_32x32x16_bf16 v[68:83], v[40:43], v[24:27], v[68:83]
    v_mfma_f32_32x32x16_bf16 v[100:115], v[36:39], v[28:31], 0
    v_mfma_f32_32x32x16_bf16 v[100:115], v[40:43], v[32:35], v[100:115]
    s_waitcnt vmcnt(4)
    s_barrier
    s_cmp_eq_u32 s30, 0
    s_cbranch_scc0 parallel_sum__softmax_full_mha__swiglu_ffn__prompt_kernel_b_hf
    s_lshl_b32 s60, s75, 2
    s_add_u32 s60, s60, 16783360
    v_mov_b32 v248, s3
    v_mov_b32 v249, 0
    buffer_store_dword v248, v249, s[20:23], s60 offen sc1
parallel_sum__softmax_full_mha__swiglu_ffn__prompt_kernel_b_hf:
    s_nop 8
    s_cmp_eq_u32 s35, 0
    s_cbranch_scc1 parallel_sum__softmax_full_mha__swiglu_ffn__prompt_kernel_b_loop_n
    buffer_load_dwordx4 v[236:239], v18, s[96:99], s46 offen
    s_waitcnt vmcnt(3) lgkmcnt(0)
    s_barrier
    ds_read_b128 v[44:47], v2 offset:16384
    ds_read_b128 v[48:51], v2 offset:17408
    v_exp_f32 v68, v68
    v_exp_f32 v69, v69
    ds_read_b128 v[60:63], v2 offset:18432
    ds_read_b128 v[64:67], v2 offset:19456
    v_exp_f32 v70, v70
    s_add_u32 m0, s41, 0
    s_add_u32 s45, s40, 49152
    buffer_load_dwordx4 v1, s[20:23], s45 offen sc1 lds
    v_exp_f32 v71, v71
    v_cvt_pk_bf16_f32 v132, v68, v69
    v_cvt_pk_bf16_f32 v133, v70, v71
    v_exp_f32 v72, v72
    v_exp_f32 v73, v73
    v_exp_f32 v74, v74
    v_exp_f32 v75, v75
    buffer_load_dwordx4 v1, s[20:23], s45 offen offset:1024 sc1 lds
    v_cvt_pk_bf16_f32 v134, v72, v73
    v_cvt_pk_bf16_f32 v135, v74, v75
    v_exp_f32 v76, v76
    v_exp_f32 v77, v77
    v_mfma_f32_32x32x16_bf16 v[148:163], v[52:55], v[132:135], 0
    v_exp_f32 v78, v78
    v_exp_f32 v79, v79
    v_cvt_pk_bf16_f32 v136, v76, v77
    v_cvt_pk_bf16_f32 v137, v78, v79
    s_waitcnt lgkmcnt(3)
    v_mfma_f32_32x32x16_bf16 v[84:99], v[44:47], v[20:23], 0
    v_exp_f32 v80, v80
    v_exp_f32 v81, v81
    v_exp_f32 v82, v82
    v_exp_f32 v83, v83
    v_cvt_pk_bf16_f32 v138, v80, v81
    v_cvt_pk_bf16_f32 v139, v82, v83
    v_exp_f32 v100, v100
    v_exp_f32 v101, v101
    v_mfma_f32_32x32x16_bf16 v[148:163], v[56:59], v[136:139], v[148:163]
    v_exp_f32 v102, v102
    v_exp_f32 v103, v103
    v_cvt_pk_bf16_f32 v140, v100, v101
    v_cvt_pk_bf16_f32 v141, v102, v103
    v_exp_f32 v104, v104
    v_exp_f32 v105, v105
    v_exp_f32 v106, v106
    v_exp_f32 v107, v107
    s_waitcnt lgkmcnt(2)
    v_mfma_f32_32x32x16_bf16 v[84:99], v[48:51], v[24:27], v[84:99]
    v_cvt_pk_bf16_f32 v142, v104, v105
    v_cvt_pk_bf16_f32 v143, v106, v107
    v_exp_f32 v108, v108
    v_exp_f32 v109, v109
    v_mfma_f32_32x32x16_bf16 v[164:179], v[52:55], v[140:143], 0
    v_exp_f32 v110, v110
    v_exp_f32 v111, v111
    v_cvt_pk_bf16_f32 v144, v108, v109
    v_cvt_pk_bf16_f32 v145, v110, v111
    v_mfma_f32_32x32x16_bf16 v[116:131], v[44:47], v[28:31], 0
    v_exp_f32 v112, v112
    v_exp_f32 v113, v113
    v_exp_f32 v114, v114
    v_exp_f32 v115, v115
    v_mfma_f32_32x32x16_bf16 v[116:131], v[48:51], v[32:35], v[116:131]
    v_cvt_pk_bf16_f32 v146, v112, v113
    v_cvt_pk_bf16_f32 v147, v114, v115
    s_waitcnt vmcnt(3) lgkmcnt(0)
    s_barrier
    s_lshr_b32 s52, s33, 1
    s_lshl_b32 s52, s52, 6
    s_add_u32 s52, s52, 16783360
    v_and_b32 v250, 15, v0
    v_lshlrev_b32 v250, 2, v250
    buffer_load_dword v251, v250, s[20:23], s52 offen sc1
    ds_read_b128 v[36:39], v2 offset:32768
    ds_read_b128 v[40:43], v2 offset:33792
    v_exp_f32 v84, v84
    v_exp_f32 v85, v85
    v_mfma_f32_32x32x16_bf16 v[164:179], v[56:59], v[144:147], v[164:179]
    ds_read_b128 v[52:55], v2 offset:34816
    ds_read_b128 v[56:59], v2 offset:35840
    v_exp_f32 v86, v86
    v_exp_f32 v87, v87
    s_add_u32 m0, s41, 16384
    s_add_u32 s45, s40, 65536
    buffer_load_dwordx4 v1, s[20:23], s45 offen sc1 lds
    v_cvt_pk_bf16_f32 v132, v84, v85
    v_cvt_pk_bf16_f32 v133, v86, v87
    v_exp_f32 v88, v88
    v_exp_f32 v89, v89
    buffer_load_dwordx4 v1, s[20:23], s45 offen offset:1024 sc1 lds
    v_exp_f32 v90, v90
    v_exp_f32 v91, v91
    v_cvt_pk_bf16_f32 v134, v88, v89
    v_cvt_pk_bf16_f32 v135, v90, v91
    v_exp_f32 v92, v92
    v_exp_f32 v93, v93
    v_mfma_f32_32x32x16_bf16 v[148:163], v[60:63], v[132:135], v[148:163]
    v_exp_f32 v94, v94
    v_exp_f32 v95, v95
    v_cvt_pk_bf16_f32 v136, v92, v93
    v_cvt_pk_bf16_f32 v137, v94, v95
    s_waitcnt lgkmcnt(3)
    v_mfma_f32_32x32x16_bf16 v[68:83], v[36:39], v[20:23], 0
    v_exp_f32 v96, v96
    v_exp_f32 v97, v97
    v_exp_f32 v98, v98
    v_exp_f32 v99, v99
    v_cvt_pk_bf16_f32 v138, v96, v97
    v_cvt_pk_bf16_f32 v139, v98, v99
    v_exp_f32 v116, v116
    v_exp_f32 v117, v117
    v_mfma_f32_32x32x16_bf16 v[148:163], v[64:67], v[136:139], v[148:163]
    v_exp_f32 v118, v118
    v_exp_f32 v119, v119
    s_mov_b32 s49, 0x200000
parallel_sum__softmax_full_mha__swiglu_ffn__prompt_kernel_b_hchk:
    s_waitcnt vmcnt(2)
    v_cmp_eq_u32 vcc, s3, v251
    s_nop 0
    s_cmp_eq_u64 vcc, -1
    s_cbranch_scc1 parallel_sum__softmax_full_mha__swiglu_ffn__prompt_kernel_b_hok
    buffer_load_dword v251, v250, s[20:23], s52 offen sc1
    s_waitcnt vmcnt(0)
    s_sub_u32 s49, s49, 1
    s_cmp_lg_u32 s49, 0
    s_cbranch_scc1 parallel_sum__softmax_full_mha__swiglu_ffn__prompt_kernel_b_hchk
parallel_sum__softmax_full_mha__swiglu_ffn__prompt_kernel_b_hok:
    v_cvt_pk_bf16_f32 v140, v116, v117
    v_cvt_pk_bf16_f32 v141, v118, v119
    s_add_u32 m0, s43, 0
    s_nop 0
    buffer_load_dwordx4 v12, s[76:79], s42 offen offset:0 sc1 lds
    v_exp_f32 v120, v120
    v_exp_f32 v121, v121
    v_exp_f32 v122, v122
    v_exp_f32 v123, v123
    s_waitcnt lgkmcnt(2)
    v_mfma_f32_32x32x16_bf16 v[68:83], v[40:43], v[24:27], v[68:83]
    buffer_load_dwordx4 v13, s[76:79], s42 offen offset:1024 sc1 lds
    v_cvt_pk_bf16_f32 v142, v120, v121
    v_cvt_pk_bf16_f32 v143, v122, v123
    v_exp_f32 v124, v124
    v_exp_f32 v125, v125
    v_mfma_f32_32x32x16_bf16 v[164:179], v[60:63], v[140:143], v[164:179]
    buffer_load_dwordx4 v14, s[76:79], s42 offen offset:2048 sc1 lds
    v_exp_f32 v126, v126
    v_exp_f32 v127, v127
    v_cvt_pk_bf16_f32 v144, v124, v125
    v_cvt_pk_bf16_f32 v145, v126, v127
    v_mfma_f32_32x32x16_bf16 v[100:115], v[36:39], v[28:31], 0
    buffer_load_dwordx4 v15, s[76:79], s42 offen offset:3072 sc1 lds
    s_add_u32 s42, s42, s44
    v_exp_f32 v128, v128
    v_exp_f32 v129, v129
    v_exp_f32 v130, v130
    v_exp_f32 v131, v131
    v_mfma_f32_32x32x16_bf16 v[100:115], v[40:43], v[32:35], v[100:115]
    v_cvt_pk_bf16_f32 v146, v128, v129
    v_cvt_pk_bf16_f32 v147, v130, v131
    s_waitcnt lgkmcnt(0)
    s_barrier
    ds_read_b128 v[44:47], v2 offset:0
    ds_read_b128 v[48:51], v2 offset:1024
    v_exp_f32 v68, v68
    v_exp_f32 v69, v69
    v_mfma_f32_32x32x16_bf16 v[164:179], v[64:67], v[144:147], v[164:179]
    ds_read_b128 v[60:63], v2 offset:2048
    ds_read_b128 v[64:67], v2 offset:3072
    v_exp_f32 v70, v70
    s_add_u32 m0, s41, 32768
    s_add_u32 s45, s40, 81920
    buffer_load_dwordx4 v1, s[20:23], s45 offen sc1 lds
    v_exp_f32 v71, v71
    v_cvt_pk_bf16_f32 v132, v68, v69
    v_cvt_pk_bf16_f32 v133, v70, v71
    v_exp_f32 v72, v72
    v_exp_f32 v73, v73
    v_exp_f32 v74, v74
    v_exp_f32 v75, v75
    buffer_load_dwordx4 v1, s[20:23], s45 offen offset:1024 sc1 lds
    v_cvt_pk_bf16_f32 v134, v72, v73
    v_cvt_pk_bf16_f32 v135, v74, v75
    v_exp_f32 v76, v76
    v_exp_f32 v77, v77
    v_mfma_f32_32x32x16_bf16 v[148:163], v[52:55], v[132:135], v[148:163]
    v_exp_f32 v78, v78
    v_exp_f32 v79, v79
    v_cvt_pk_bf16_f32 v136, v76, v77
    s_add_u32 m0, s43, 32768
    s_nop 0
    buffer_load_dwordx4 v12, s[76:79], s42 offen offset:0 sc1 lds
    v_cvt_pk_bf16_f32 v137, v78, v79
    s_waitcnt lgkmcnt(3)
    v_mfma_f32_32x32x16_bf16 v[84:99], v[44:47], v[20:23], 0
    v_exp_f32 v80, v80
    v_exp_f32 v81, v81
    v_exp_f32 v82, v82
    v_exp_f32 v83, v83
    v_cvt_pk_bf16_f32 v138, v80, v81
    v_cvt_pk_bf16_f32 v139, v82, v83
    buffer_load_dwordx4 v13, s[76:79], s42 offen offset:1024 sc1 lds
    v_exp_f32 v100, v100
    v_exp_f32 v101, v101
    v_mfma_f32_32x32x16_bf16 v[148:163], v[56:59], v[136:139], v[148:163]
    v_exp_f32 v102, v102
    v_exp_f32 v103, v103
    v_cvt_pk_bf16_f32 v140, v100, v101
    v_cvt_pk_bf16_f32 v141, v102, v103
    v_exp_f32 v104, v104
    buffer_load_dwordx4 v14, s[76:79], s42 offen offset:2048 sc1 lds
    v_exp_f32 v105, v105
    v_exp_f32 v106, v106
    v_exp_f32 v107, v107
    s_waitcnt lgkmcnt(2)
    v_mfma_f32_32x32x16_bf16 v[84:99], v[48:51], v[24:27], v[84:99]
    v_cvt_pk_bf16_f32 v142, v104, v105
    v_cvt_pk_bf16_f32 v143, v106, v107
    v_exp_f32 v108, v108
    v_exp_f32 v109, v109
    v_mfma_f32_32x32x16_bf16 v[164:179], v[52:55], v[140:143], v[164:179]
    buffer_load_dwordx4 v15, s[76:79], s42 offen offset:3072 sc1 lds
    s_add_u32 s42, s42, s44
    v_exp_f32 v110, v110
    v_exp_f32 v111, v111
    v_cvt_pk_bf16_f32 v144, v108, v109
    v_cvt_pk_bf16_f32 v145, v110, v111
    v_mfma_f32_32x32x16_bf16 v[116:131], v[44:47], v[28:31], 0
    v_exp_f32 v112, v112
    v_exp_f32 v113, v113
    v_exp_f32 v114, v114
    v_exp_f32 v115, v115
    v_mfma_f32_32x32x16_bf16 v[116:131], v[48:51], v[32:35], v[116:131]
    v_cvt_pk_bf16_f32 v146, v112, v113
    v_cvt_pk_bf16_f32 v147, v114, v115
    s_waitcnt vmcnt(6) lgkmcnt(0)
    s_barrier
    ds_read_b128 v[36:39], v2 offset:16384
    ds_read_b128 v[40:43], v2 offset:17408
    v_exp_f32 v84, v84
    v_exp_f32 v85, v85
    v_mfma_f32_32x32x16_bf16 v[164:179], v[56:59], v[144:147], v[164:179]
    ds_read_b128 v[52:55], v2 offset:18432
    ds_read_b128 v[56:59], v2 offset:19456
    v_exp_f32 v86, v86
    s_add_u32 m0, s41, 0
    s_add_u32 s45, s40, 98304
    buffer_load_dwordx4 v1, s[20:23], s45 offen sc1 lds
    v_exp_f32 v87, v87
    v_cvt_pk_bf16_f32 v132, v84, v85
    v_cvt_pk_bf16_f32 v133, v86, v87
    v_exp_f32 v88, v88
    v_exp_f32 v89, v89
    v_exp_f32 v90, v90
    v_exp_f32 v91, v91
    buffer_load_dwordx4 v1, s[20:23], s45 offen offset:1024 sc1 lds
    v_cvt_pk_bf16_f32 v134, v88, v89
    ds_read_b64_tr_b16 v[228:229], v9 offset:0
    ds_read_b64_tr_b16 v[230:231], v9 offset:1024
    ds_read_b128 v[212:215], v3 offset:0
    ds_read_b128 v[216:219], v3 offset:8192
    v_cvt_pk_bf16_f32 v135, v90, v91
    v_exp_f32 v92, v92
    v_exp_f32 v93, v93
    v_mfma_f32_32x32x16_bf16 v[148:163], v[60:63], v[132:135], v[148:163]
    v_exp_f32 v94, v94
    v_exp_f32 v95, v95
    v_cvt_pk_bf16_f32 v136, v92, v93
    s_add_u32 m0, s43, 65536
    s_nop 0
    buffer_load_dwordx4 v12, s[76:79], s42 offen offset:0 sc1 lds
    v_cvt_pk_bf16_f32 v137, v94, v95
    s_waitcnt lgkmcnt(7)
    v_mfma_f32_32x32x16_bf16 v[68:83], v[36:39], v[20:23], 0
    v_exp_f32 v96, v96
    v_exp_f32 v97, v97
    v_exp_f32 v98, v98
    v_exp_f32 v99, v99
    v_cvt_pk_bf16_f32 v138, v96, v97
    v_cvt_pk_bf16_f32 v139, v98, v99
    buffer_load_dwordx4 v13, s[76:79], s42 offen offset:1024 sc1 lds
    v_exp_f32 v116, v116
    v_exp_f32 v117, v117
    v_mfma_f32_32x32x16_bf16 v[148:163], v[64:67], v[136:139], v[148:163]
    v_exp_f32 v118, v118
    v_exp_f32 v119, v119
    v_cvt_pk_bf16_f32 v140, v116, v117
    v_cvt_pk_bf16_f32 v141, v118, v119
    v_exp_f32 v120, v120
    ds_read_b64_tr_b16 v[232:233], v9 offset:2048
    ds_read_b64_tr_b16 v[234:235], v9 offset:3072
    ds_read_b128 v[220:223], v3 offset:1024
    ds_read_b128 v[224:227], v3 offset:9216
    buffer_load_dwordx4 v14, s[76:79], s42 offen offset:2048 sc1 lds
    v_exp_f32 v121, v121
    v_exp_f32 v122, v122
    v_exp_f32 v123, v123
    s_waitcnt lgkmcnt(10)
    v_mfma_f32_32x32x16_bf16 v[68:83], v[40:43], v[24:27], v[68:83]
    v_cvt_pk_bf16_f32 v142, v120, v121
    v_cvt_pk_bf16_f32 v143, v122, v123
    v_exp_f32 v124, v124
    v_exp_f32 v125, v125
    v_mfma_f32_32x32x16_bf16 v[164:179], v[60:63], v[140:143], v[164:179]
    buffer_load_dwordx4 v15, s[76:79], s42 offen offset:3072 sc1 lds
    s_add_u32 s42, s42, s44
    v_exp_f32 v126, v126
    v_exp_f32 v127, v127
    v_cvt_pk_bf16_f32 v144, v124, v125
    v_cvt_pk_bf16_f32 v145, v126, v127
    v_mfma_f32_32x32x16_bf16 v[100:115], v[36:39], v[28:31], 0
    v_exp_f32 v128, v128
    v_exp_f32 v129, v129
    v_exp_f32 v130, v130
    v_exp_f32 v131, v131
    v_mfma_f32_32x32x16_bf16 v[100:115], v[40:43], v[32:35], v[100:115]
    v_cvt_pk_bf16_f32 v146, v128, v129
    v_cvt_pk_bf16_f32 v147, v130, v131
    s_waitcnt vmcnt(6) lgkmcnt(0)
    s_barrier
    ds_read_b128 v[44:47], v2 offset:32768
    ds_read_b128 v[48:51], v2 offset:33792
    v_exp_f32 v68, v68
    v_exp_f32 v69, v69
    v_mfma_f32_32x32x16_bf16 v[164:179], v[64:67], v[144:147], v[164:179]
    ds_read_b128 v[60:63], v2 offset:34816
    ds_read_b128 v[64:67], v2 offset:35840
    v_exp_f32 v70, v70
    s_add_u32 m0, s41, 16384
    s_add_u32 s45, s40, 114688
    buffer_load_dwordx4 v1, s[20:23], s45 offen sc1 lds
    v_exp_f32 v71, v71
    v_cvt_pk_bf16_f32 v132, v68, v69
    v_cvt_pk_bf16_f32 v133, v70, v71
    v_mfma_f32_32x32x16_bf16 v[180:195], v[228:231], v[212:215], 0
    v_exp_f32 v72, v72
    v_exp_f32 v73, v73
    v_exp_f32 v74, v74
    v_exp_f32 v75, v75
    v_mfma_f32_32x32x16_bf16 v[196:211], v[228:231], v[216:219], 0
    buffer_load_dwordx4 v1, s[20:23], s45 offen offset:1024 sc1 lds
    v_cvt_pk_bf16_f32 v134, v72, v73
    ds_read_b64_tr_b16 v[228:229], v10 offset:0
    ds_read_b64_tr_b16 v[230:231], v10 offset:1024
    ds_read_b128 v[212:215], v4 offset:0
    ds_read_b128 v[216:219], v4 offset:8192
    v_cvt_pk_bf16_f32 v135, v74, v75
    v_exp_f32 v76, v76
    v_exp_f32 v77, v77
    v_mfma_f32_32x32x16_bf16 v[148:163], v[52:55], v[132:135], v[148:163]
    v_exp_f32 v78, v78
    v_exp_f32 v79, v79
    v_cvt_pk_bf16_f32 v136, v76, v77
    s_add_u32 m0, s43, 0
    s_nop 0
    buffer_load_dwordx4 v12, s[76:79], s42 offen offset:0 sc1 lds
    v_cvt_pk_bf16_f32 v137, v78, v79
    s_waitcnt lgkmcnt(7)
    v_mfma_f32_32x32x16_bf16 v[84:99], v[44:47], v[20:23], 0
    v_exp_f32 v80, v80
    v_exp_f32 v81, v81
    v_exp_f32 v82, v82
    v_exp_f32 v83, v83
    v_mfma_f32_32x32x16_bf16 v[180:195], v[232:235], v[220:223], v[180:195]
    v_cvt_pk_bf16_f32 v138, v80, v81
    v_cvt_pk_bf16_f32 v139, v82, v83
    buffer_load_dwordx4 v13, s[76:79], s42 offen offset:1024 sc1 lds
    v_exp_f32 v100, v100
    v_exp_f32 v101, v101
    v_mfma_f32_32x32x16_bf16 v[148:163], v[56:59], v[136:139], v[148:163]
    v_exp_f32 v102, v102
    v_exp_f32 v103, v103
    v_cvt_pk_bf16_f32 v140, v100, v101
    v_cvt_pk_bf16_f32 v141, v102, v103
    v_mfma_f32_32x32x16_bf16 v[196:211], v[232:235], v[224:227], v[196:211]
    v_exp_f32 v104, v104
    ds_read_b64_tr_b16 v[232:233], v10 offset:2048
    ds_read_b64_tr_b16 v[234:235], v10 offset:3072
    ds_read_b128 v[220:223], v4 offset:1024
    ds_read_b128 v[224:227], v4 offset:9216
    buffer_load_dwordx4 v14, s[76:79], s42 offen offset:2048 sc1 lds
    v_exp_f32 v105, v105
    v_exp_f32 v106, v106
    v_exp_f32 v107, v107
    s_waitcnt lgkmcnt(10)
    v_mfma_f32_32x32x16_bf16 v[84:99], v[48:51], v[24:27], v[84:99]
    v_cvt_pk_bf16_f32 v142, v104, v105
    v_cvt_pk_bf16_f32 v143, v106, v107
    v_exp_f32 v108, v108
    v_exp_f32 v109, v109
    v_mfma_f32_32x32x16_bf16 v[164:179], v[52:55], v[140:143], v[164:179]
    buffer_load_dwordx4 v15, s[76:79], s42 offen offset:3072 sc1 lds
    s_add_u32 s42, s42, s44
    v_exp_f32 v110, v110
    v_exp_f32 v111, v111
    v_cvt_pk_bf16_f32 v144, v108, v109
    v_cvt_pk_bf16_f32 v145, v110, v111
    v_mfma_f32_32x32x16_bf16 v[116:131], v[44:47], v[28:31], 0
    v_exp_f32 v112, v112
    v_exp_f32 v113, v113
    v_exp_f32 v114, v114
    v_exp_f32 v115, v115
    v_mfma_f32_32x32x16_bf16 v[116:131], v[48:51], v[32:35], v[116:131]
    v_cvt_pk_bf16_f32 v146, v112, v113
    v_cvt_pk_bf16_f32 v147, v114, v115
    s_waitcnt vmcnt(6) lgkmcnt(0)
    s_barrier
    ds_read_b128 v[36:39], v2 offset:0
    ds_read_b128 v[40:43], v2 offset:1024
    v_exp_f32 v84, v84
    v_exp_f32 v85, v85
    v_mfma_f32_32x32x16_bf16 v[164:179], v[56:59], v[144:147], v[164:179]
    ds_read_b128 v[52:55], v2 offset:2048
    ds_read_b128 v[56:59], v2 offset:3072
    v_exp_f32 v86, v86
    s_add_u32 m0, s41, 32768
    s_add_u32 s45, s40, 131072
    buffer_load_dwordx4 v1, s[20:23], s45 offen sc1 lds
    v_exp_f32 v87, v87
    v_cvt_pk_bf16_f32 v132, v84, v85
    v_cvt_pk_bf16_f32 v133, v86, v87
    v_mfma_f32_32x32x16_bf16 v[180:195], v[228:231], v[212:215], v[180:195]
    v_exp_f32 v88, v88
    v_exp_f32 v89, v89
    v_exp_f32 v90, v90
    v_exp_f32 v91, v91
    v_mfma_f32_32x32x16_bf16 v[196:211], v[228:231], v[216:219], v[196:211]
    buffer_load_dwordx4 v1, s[20:23], s45 offen offset:1024 sc1 lds
    v_cvt_pk_bf16_f32 v134, v88, v89
    ds_read_b64_tr_b16 v[228:229], v11 offset:0
    ds_read_b64_tr_b16 v[230:231], v11 offset:1024
    ds_read_b128 v[212:215], v8 offset:0
    ds_read_b128 v[216:219], v8 offset:8192
    v_cvt_pk_bf16_f32 v135, v90, v91
    v_exp_f32 v92, v92
    v_exp_f32 v93, v93
    v_mfma_f32_32x32x16_bf16 v[148:163], v[60:63], v[132:135], v[148:163]
    v_exp_f32 v94, v94
    v_exp_f32 v95, v95
    v_cvt_pk_bf16_f32 v136, v92, v93
    s_add_u32 m0, s43, 32768
    s_nop 0
    buffer_load_dwordx4 v12, s[76:79], s42 offen offset:0 sc1 lds
    v_cvt_pk_bf16_f32 v137, v94, v95
    s_waitcnt lgkmcnt(7)
    v_mfma_f32_32x32x16_bf16 v[68:83], v[36:39], v[20:23], 0
    v_exp_f32 v96, v96
    v_exp_f32 v97, v97
    v_exp_f32 v98, v98
    v_exp_f32 v99, v99
    v_mfma_f32_32x32x16_bf16 v[180:195], v[232:235], v[220:223], v[180:195]
    v_cvt_pk_bf16_f32 v138, v96, v97
    v_cvt_pk_bf16_f32 v139, v98, v99
    buffer_load_dwordx4 v13, s[76:79], s42 offen offset:1024 sc1 lds
    v_exp_f32 v116, v116
    v_exp_f32 v117, v117
    v_mfma_f32_32x32x16_bf16 v[148:163], v[64:67], v[136:139], v[148:163]
    v_exp_f32 v118, v118
    v_exp_f32 v119, v119
    v_cvt_pk_bf16_f32 v140, v116, v117
    v_cvt_pk_bf16_f32 v141, v118, v119
    v_mfma_f32_32x32x16_bf16 v[196:211], v[232:235], v[224:227], v[196:211]
    v_exp_f32 v120, v120
    ds_read_b64_tr_b16 v[232:233], v11 offset:2048
    ds_read_b64_tr_b16 v[234:235], v11 offset:3072
    ds_read_b128 v[220:223], v8 offset:1024
    ds_read_b128 v[224:227], v8 offset:9216
    buffer_load_dwordx4 v14, s[76:79], s42 offen offset:2048 sc1 lds
    v_exp_f32 v121, v121
    v_exp_f32 v122, v122
    v_exp_f32 v123, v123
    s_waitcnt lgkmcnt(10)
    v_mfma_f32_32x32x16_bf16 v[68:83], v[40:43], v[24:27], v[68:83]
    v_cvt_pk_bf16_f32 v142, v120, v121
    v_cvt_pk_bf16_f32 v143, v122, v123
    v_exp_f32 v124, v124
    v_exp_f32 v125, v125
    v_mfma_f32_32x32x16_bf16 v[164:179], v[60:63], v[140:143], v[164:179]
    buffer_load_dwordx4 v15, s[76:79], s42 offen offset:3072 sc1 lds
    s_add_u32 s42, s42, s44
    v_exp_f32 v126, v126
    v_exp_f32 v127, v127
    v_cvt_pk_bf16_f32 v144, v124, v125
    v_cvt_pk_bf16_f32 v145, v126, v127
    v_mfma_f32_32x32x16_bf16 v[100:115], v[36:39], v[28:31], 0
    v_exp_f32 v128, v128
    v_exp_f32 v129, v129
    v_exp_f32 v130, v130
    v_exp_f32 v131, v131
    v_mfma_f32_32x32x16_bf16 v[100:115], v[40:43], v[32:35], v[100:115]
    v_cvt_pk_bf16_f32 v146, v128, v129
    v_cvt_pk_bf16_f32 v147, v130, v131
    s_waitcnt vmcnt(6) lgkmcnt(0)
    s_barrier
    ds_read_b128 v[44:47], v2 offset:16384
    ds_read_b128 v[48:51], v2 offset:17408
    v_exp_f32 v68, v68
    v_exp_f32 v69, v69
    v_mfma_f32_32x32x16_bf16 v[164:179], v[64:67], v[144:147], v[164:179]
    ds_read_b128 v[60:63], v2 offset:18432
    ds_read_b128 v[64:67], v2 offset:19456
    v_exp_f32 v70, v70
    s_add_u32 m0, s41, 0
    s_add_u32 s45, s40, 147456
    buffer_load_dwordx4 v1, s[20:23], s45 offen sc1 lds
    v_exp_f32 v71, v71
    v_cvt_pk_bf16_f32 v132, v68, v69
    v_cvt_pk_bf16_f32 v133, v70, v71
    v_mfma_f32_32x32x16_bf16 v[180:195], v[228:231], v[212:215], v[180:195]
    v_exp_f32 v72, v72
    v_exp_f32 v73, v73
    v_exp_f32 v74, v74
    v_exp_f32 v75, v75
    v_mfma_f32_32x32x16_bf16 v[196:211], v[228:231], v[216:219], v[196:211]
    buffer_load_dwordx4 v1, s[20:23], s45 offen offset:1024 sc1 lds
    v_cvt_pk_bf16_f32 v134, v72, v73
    ds_read_b64_tr_b16 v[228:229], v9 offset:0
    ds_read_b64_tr_b16 v[230:231], v9 offset:1024
    ds_read_b128 v[212:215], v3 offset:0
    ds_read_b128 v[216:219], v3 offset:8192
    v_cvt_pk_bf16_f32 v135, v74, v75
    v_exp_f32 v76, v76
    v_exp_f32 v77, v77
    v_mfma_f32_32x32x16_bf16 v[148:163], v[52:55], v[132:135], v[148:163]
    v_exp_f32 v78, v78
    v_exp_f32 v79, v79
    v_cvt_pk_bf16_f32 v136, v76, v77
    s_add_u32 m0, s43, 65536
    s_nop 0
    buffer_load_dwordx4 v12, s[76:79], s42 offen offset:0 sc1 lds
    v_cvt_pk_bf16_f32 v137, v78, v79
    s_waitcnt lgkmcnt(7)
    v_mfma_f32_32x32x16_bf16 v[84:99], v[44:47], v[20:23], 0
    v_exp_f32 v80, v80
    v_exp_f32 v81, v81
    v_exp_f32 v82, v82
    v_exp_f32 v83, v83
    v_mfma_f32_32x32x16_bf16 v[180:195], v[232:235], v[220:223], v[180:195]
    v_cvt_pk_bf16_f32 v138, v80, v81
    v_cvt_pk_bf16_f32 v139, v82, v83
    buffer_load_dwordx4 v13, s[76:79], s42 offen offset:1024 sc1 lds
    v_exp_f32 v100, v100
    v_exp_f32 v101, v101
    v_mfma_f32_32x32x16_bf16 v[148:163], v[56:59], v[136:139], v[148:163]
    v_exp_f32 v102, v102
    v_exp_f32 v103, v103
    v_cvt_pk_bf16_f32 v140, v100, v101
    v_cvt_pk_bf16_f32 v141, v102, v103
    v_mfma_f32_32x32x16_bf16 v[196:211], v[232:235], v[224:227], v[196:211]
    v_exp_f32 v104, v104
    ds_read_b64_tr_b16 v[232:233], v9 offset:2048
    ds_read_b64_tr_b16 v[234:235], v9 offset:3072
    ds_read_b128 v[220:223], v3 offset:1024
    ds_read_b128 v[224:227], v3 offset:9216
    buffer_load_dwordx4 v14, s[76:79], s42 offen offset:2048 sc1 lds
    v_exp_f32 v105, v105
    v_exp_f32 v106, v106
    v_exp_f32 v107, v107
    s_waitcnt lgkmcnt(10)
    v_mfma_f32_32x32x16_bf16 v[84:99], v[48:51], v[24:27], v[84:99]
    v_cvt_pk_bf16_f32 v142, v104, v105
    v_cvt_pk_bf16_f32 v143, v106, v107
    v_exp_f32 v108, v108
    v_exp_f32 v109, v109
    v_mfma_f32_32x32x16_bf16 v[164:179], v[52:55], v[140:143], v[164:179]
    buffer_load_dwordx4 v15, s[76:79], s42 offen offset:3072 sc1 lds
    s_add_u32 s42, s42, s44
    v_exp_f32 v110, v110
    v_exp_f32 v111, v111
    v_cvt_pk_bf16_f32 v144, v108, v109
    v_cvt_pk_bf16_f32 v145, v110, v111
    v_mfma_f32_32x32x16_bf16 v[116:131], v[44:47], v[28:31], 0
    v_exp_f32 v112, v112
    v_exp_f32 v113, v113
    v_exp_f32 v114, v114
    v_exp_f32 v115, v115
    v_mfma_f32_32x32x16_bf16 v[116:131], v[48:51], v[32:35], v[116:131]
    v_cvt_pk_bf16_f32 v146, v112, v113
    v_cvt_pk_bf16_f32 v147, v114, v115
    s_waitcnt vmcnt(6) lgkmcnt(0)
    s_barrier
    ds_read_b128 v[36:39], v2 offset:32768
    ds_read_b128 v[40:43], v2 offset:33792
    v_exp_f32 v84, v84
    v_exp_f32 v85, v85
    v_mfma_f32_32x32x16_bf16 v[164:179], v[56:59], v[144:147], v[164:179]
    ds_read_b128 v[52:55], v2 offset:34816
    ds_read_b128 v[56:59], v2 offset:35840
    v_exp_f32 v86, v86
    s_add_u32 m0, s41, 16384
    s_add_u32 s45, s40, 163840
    buffer_load_dwordx4 v1, s[20:23], s45 offen sc1 lds
    v_exp_f32 v87, v87
    v_cvt_pk_bf16_f32 v132, v84, v85
    v_cvt_pk_bf16_f32 v133, v86, v87
    v_mfma_f32_32x32x16_bf16 v[180:195], v[228:231], v[212:215], v[180:195]
    v_exp_f32 v88, v88
    v_exp_f32 v89, v89
    v_exp_f32 v90, v90
    v_exp_f32 v91, v91
    v_mfma_f32_32x32x16_bf16 v[196:211], v[228:231], v[216:219], v[196:211]
    buffer_load_dwordx4 v1, s[20:23], s45 offen offset:1024 sc1 lds
    v_cvt_pk_bf16_f32 v134, v88, v89
    ds_read_b64_tr_b16 v[228:229], v10 offset:0
    ds_read_b64_tr_b16 v[230:231], v10 offset:1024
    ds_read_b128 v[212:215], v4 offset:0
    ds_read_b128 v[216:219], v4 offset:8192
    v_cvt_pk_bf16_f32 v135, v90, v91
    v_exp_f32 v92, v92
    v_exp_f32 v93, v93
    v_mfma_f32_32x32x16_bf16 v[148:163], v[60:63], v[132:135], v[148:163]
    v_exp_f32 v94, v94
    v_exp_f32 v95, v95
    v_cvt_pk_bf16_f32 v136, v92, v93
    s_add_u32 m0, s43, 0
    s_nop 0
    buffer_load_dwordx4 v12, s[76:79], s42 offen offset:0 sc1 lds
    v_cvt_pk_bf16_f32 v137, v94, v95
    s_waitcnt lgkmcnt(7)
    v_mfma_f32_32x32x16_bf16 v[68:83], v[36:39], v[20:23], 0
    v_exp_f32 v96, v96
    v_exp_f32 v97, v97
    v_exp_f32 v98, v98
    v_exp_f32 v99, v99
    v_mfma_f32_32x32x16_bf16 v[180:195], v[232:235], v[220:223], v[180:195]
    v_cvt_pk_bf16_f32 v138, v96, v97
    v_cvt_pk_bf16_f32 v139, v98, v99
    buffer_load_dwordx4 v13, s[76:79], s42 offen offset:1024 sc1 lds
    v_exp_f32 v116, v116
    v_exp_f32 v117, v117
    v_mfma_f32_32x32x16_bf16 v[148:163], v[64:67], v[136:139], v[148:163]
    v_exp_f32 v118, v118
    v_exp_f32 v119, v119
    v_cvt_pk_bf16_f32 v140, v116, v117
    v_cvt_pk_bf16_f32 v141, v118, v119
    v_mfma_f32_32x32x16_bf16 v[196:211], v[232:235], v[224:227], v[196:211]
    v_exp_f32 v120, v120
    ds_read_b64_tr_b16 v[232:233], v10 offset:2048
    ds_read_b64_tr_b16 v[234:235], v10 offset:3072
    ds_read_b128 v[220:223], v4 offset:1024
    ds_read_b128 v[224:227], v4 offset:9216
    buffer_load_dwordx4 v14, s[76:79], s42 offen offset:2048 sc1 lds
    v_exp_f32 v121, v121
    v_exp_f32 v122, v122
    v_exp_f32 v123, v123
    s_waitcnt lgkmcnt(10)
    v_mfma_f32_32x32x16_bf16 v[68:83], v[40:43], v[24:27], v[68:83]
    v_cvt_pk_bf16_f32 v142, v120, v121
    v_cvt_pk_bf16_f32 v143, v122, v123
    v_exp_f32 v124, v124
    v_exp_f32 v125, v125
    v_mfma_f32_32x32x16_bf16 v[164:179], v[60:63], v[140:143], v[164:179]
    buffer_load_dwordx4 v15, s[76:79], s42 offen offset:3072 sc1 lds
    s_add_u32 s42, s42, s44
    v_exp_f32 v126, v126
    v_exp_f32 v127, v127
    v_cvt_pk_bf16_f32 v144, v124, v125
    v_cvt_pk_bf16_f32 v145, v126, v127
    v_mfma_f32_32x32x16_bf16 v[100:115], v[36:39], v[28:31], 0
    v_exp_f32 v128, v128
    v_exp_f32 v129, v129
    v_exp_f32 v130, v130
    v_exp_f32 v131, v131
    v_mfma_f32_32x32x16_bf16 v[100:115], v[40:43], v[32:35], v[100:115]
    v_cvt_pk_bf16_f32 v146, v128, v129
    v_cvt_pk_bf16_f32 v147, v130, v131
    s_waitcnt vmcnt(6) lgkmcnt(0)
    s_barrier
    ds_read_b128 v[44:47], v2 offset:0
    ds_read_b128 v[48:51], v2 offset:1024
    v_exp_f32 v68, v68
    v_exp_f32 v69, v69
    v_mfma_f32_32x32x16_bf16 v[164:179], v[64:67], v[144:147], v[164:179]
    ds_read_b128 v[60:63], v2 offset:2048
    ds_read_b128 v[64:67], v2 offset:3072
    v_exp_f32 v70, v70
    s_add_u32 m0, s41, 32768
    s_add_u32 s45, s40, 180224
    buffer_load_dwordx4 v1, s[20:23], s45 offen sc1 lds
    v_exp_f32 v71, v71
    v_cvt_pk_bf16_f32 v132, v68, v69
    v_cvt_pk_bf16_f32 v133, v70, v71
    v_mfma_f32_32x32x16_bf16 v[180:195], v[228:231], v[212:215], v[180:195]
    v_exp_f32 v72, v72
    v_exp_f32 v73, v73
    v_exp_f32 v74, v74
    v_exp_f32 v75, v75
    v_mfma_f32_32x32x16_bf16 v[196:211], v[228:231], v[216:219], v[196:211]
    buffer_load_dwordx4 v1, s[20:23], s45 offen offset:1024 sc1 lds
    v_cvt_pk_bf16_f32 v134, v72, v73
    ds_read_b64_tr_b16 v[228:229], v11 offset:0
    ds_read_b64_tr_b16 v[230:231], v11 offset:1024
    ds_read_b128 v[212:215], v8 offset:0
    ds_read_b128 v[216:219], v8 offset:8192
    v_cvt_pk_bf16_f32 v135, v74, v75
    v_exp_f32 v76, v76
    v_exp_f32 v77, v77
    v_mfma_f32_32x32x16_bf16 v[148:163], v[52:55], v[132:135], v[148:163]
    v_exp_f32 v78, v78
    v_exp_f32 v79, v79
    v_cvt_pk_bf16_f32 v136, v76, v77
    s_add_u32 m0, s43, 32768
    s_nop 0
    buffer_load_dwordx4 v12, s[76:79], s42 offen offset:0 sc1 lds
    v_cvt_pk_bf16_f32 v137, v78, v79
    s_waitcnt lgkmcnt(7)
    v_mfma_f32_32x32x16_bf16 v[84:99], v[44:47], v[20:23], 0
    v_exp_f32 v80, v80
    v_exp_f32 v81, v81
    v_exp_f32 v82, v82
    v_exp_f32 v83, v83
    v_mfma_f32_32x32x16_bf16 v[180:195], v[232:235], v[220:223], v[180:195]
    v_cvt_pk_bf16_f32 v138, v80, v81
    v_cvt_pk_bf16_f32 v139, v82, v83
    buffer_load_dwordx4 v13, s[76:79], s42 offen offset:1024 sc1 lds
    v_exp_f32 v100, v100
    v_exp_f32 v101, v101
    v_mfma_f32_32x32x16_bf16 v[148:163], v[56:59], v[136:139], v[148:163]
    v_exp_f32 v102, v102
    v_exp_f32 v103, v103
    v_cvt_pk_bf16_f32 v140, v100, v101
    v_cvt_pk_bf16_f32 v141, v102, v103
    v_mfma_f32_32x32x16_bf16 v[196:211], v[232:235], v[224:227], v[196:211]
    v_exp_f32 v104, v104
    ds_read_b64_tr_b16 v[232:233], v11 offset:2048
    ds_read_b64_tr_b16 v[234:235], v11 offset:3072
    ds_read_b128 v[220:223], v8 offset:1024
    ds_read_b128 v[224:227], v8 offset:9216
    buffer_load_dwordx4 v14, s[76:79], s42 offen offset:2048 sc1 lds
    v_exp_f32 v105, v105
    v_exp_f32 v106, v106
    v_exp_f32 v107, v107
    s_waitcnt lgkmcnt(10)
    v_mfma_f32_32x32x16_bf16 v[84:99], v[48:51], v[24:27], v[84:99]
    v_cvt_pk_bf16_f32 v142, v104, v105
    v_cvt_pk_bf16_f32 v143, v106, v107
    v_exp_f32 v108, v108
    v_exp_f32 v109, v109
    v_mfma_f32_32x32x16_bf16 v[164:179], v[52:55], v[140:143], v[164:179]
    buffer_load_dwordx4 v15, s[76:79], s42 offen offset:3072 sc1 lds
    s_add_u32 s42, s42, s44
    v_exp_f32 v110, v110
    v_exp_f32 v111, v111
    v_cvt_pk_bf16_f32 v144, v108, v109
    v_cvt_pk_bf16_f32 v145, v110, v111
    v_mfma_f32_32x32x16_bf16 v[116:131], v[44:47], v[28:31], 0
    v_exp_f32 v112, v112
    v_exp_f32 v113, v113
    v_exp_f32 v114, v114
    v_exp_f32 v115, v115
    v_mfma_f32_32x32x16_bf16 v[116:131], v[48:51], v[32:35], v[116:131]
    v_cvt_pk_bf16_f32 v146, v112, v113
    v_cvt_pk_bf16_f32 v147, v114, v115
    s_waitcnt vmcnt(6) lgkmcnt(0)
    s_barrier
    ds_read_b128 v[36:39], v2 offset:16384
    ds_read_b128 v[40:43], v2 offset:17408
    v_exp_f32 v84, v84
    v_exp_f32 v85, v85
    v_mfma_f32_32x32x16_bf16 v[164:179], v[56:59], v[144:147], v[164:179]
    ds_read_b128 v[52:55], v2 offset:18432
    ds_read_b128 v[56:59], v2 offset:19456
    v_exp_f32 v86, v86
    s_add_u32 m0, s41, 0
    s_add_u32 s45, s40, 196608
    buffer_load_dwordx4 v1, s[20:23], s45 offen sc1 lds
    v_exp_f32 v87, v87
    v_cvt_pk_bf16_f32 v132, v84, v85
    v_cvt_pk_bf16_f32 v133, v86, v87
    v_mfma_f32_32x32x16_bf16 v[180:195], v[228:231], v[212:215], v[180:195]
    v_exp_f32 v88, v88
    v_exp_f32 v89, v89
    v_exp_f32 v90, v90
    v_exp_f32 v91, v91
    v_mfma_f32_32x32x16_bf16 v[196:211], v[228:231], v[216:219], v[196:211]
    buffer_load_dwordx4 v1, s[20:23], s45 offen offset:1024 sc1 lds
    v_cvt_pk_bf16_f32 v134, v88, v89
    ds_read_b64_tr_b16 v[228:229], v9 offset:0
    ds_read_b64_tr_b16 v[230:231], v9 offset:1024
    ds_read_b128 v[212:215], v3 offset:0
    ds_read_b128 v[216:219], v3 offset:8192
    v_cvt_pk_bf16_f32 v135, v90, v91
    v_exp_f32 v92, v92
    v_exp_f32 v93, v93
    v_mfma_f32_32x32x16_bf16 v[148:163], v[60:63], v[132:135], v[148:163]
    v_exp_f32 v94, v94
    v_exp_f32 v95, v95
    v_cvt_pk_bf16_f32 v136, v92, v93
    s_add_u32 m0, s43, 65536
    s_nop 0
    buffer_load_dwordx4 v12, s[76:79], s42 offen offset:0 sc1 lds
    v_cvt_pk_bf16_f32 v137, v94, v95
    s_waitcnt lgkmcnt(7)
    v_mfma_f32_32x32x16_bf16 v[68:83], v[36:39], v[20:23], 0
    v_exp_f32 v96, v96
    v_exp_f32 v97, v97
    v_exp_f32 v98, v98
    v_exp_f32 v99, v99
    v_mfma_f32_32x32x16_bf16 v[180:195], v[232:235], v[220:223], v[180:195]
    v_cvt_pk_bf16_f32 v138, v96, v97
    v_cvt_pk_bf16_f32 v139, v98, v99
    buffer_load_dwordx4 v13, s[76:79], s42 offen offset:1024 sc1 lds
    v_exp_f32 v116, v116
    v_exp_f32 v117, v117
    v_mfma_f32_32x32x16_bf16 v[148:163], v[64:67], v[136:139], v[148:163]
    v_exp_f32 v118, v118
    v_exp_f32 v119, v119
    v_cvt_pk_bf16_f32 v140, v116, v117
    v_cvt_pk_bf16_f32 v141, v118, v119
    v_mfma_f32_32x32x16_bf16 v[196:211], v[232:235], v[224:227], v[196:211]
    v_exp_f32 v120, v120
    ds_read_b64_tr_b16 v[232:233], v9 offset:2048
    ds_read_b64_tr_b16 v[234:235], v9 offset:3072
    ds_read_b128 v[220:223], v3 offset:1024
    ds_read_b128 v[224:227], v3 offset:9216
    buffer_load_dwordx4 v14, s[76:79], s42 offen offset:2048 sc1 lds
    v_exp_f32 v121, v121
    v_exp_f32 v122, v122
    v_exp_f32 v123, v123
    s_waitcnt lgkmcnt(10)
    v_mfma_f32_32x32x16_bf16 v[68:83], v[40:43], v[24:27], v[68:83]
    v_cvt_pk_bf16_f32 v142, v120, v121
    v_cvt_pk_bf16_f32 v143, v122, v123
    v_exp_f32 v124, v124
    v_exp_f32 v125, v125
    v_mfma_f32_32x32x16_bf16 v[164:179], v[60:63], v[140:143], v[164:179]
    buffer_load_dwordx4 v15, s[76:79], s42 offen offset:3072 sc1 lds
    s_add_u32 s42, s42, s44
    v_exp_f32 v126, v126
    v_exp_f32 v127, v127
    v_cvt_pk_bf16_f32 v144, v124, v125
    v_cvt_pk_bf16_f32 v145, v126, v127
    v_mfma_f32_32x32x16_bf16 v[100:115], v[36:39], v[28:31], 0
    v_exp_f32 v128, v128
    v_exp_f32 v129, v129
    v_exp_f32 v130, v130
    v_exp_f32 v131, v131
    v_mfma_f32_32x32x16_bf16 v[100:115], v[40:43], v[32:35], v[100:115]
    v_cvt_pk_bf16_f32 v146, v128, v129
    v_cvt_pk_bf16_f32 v147, v130, v131
    s_waitcnt vmcnt(6) lgkmcnt(0)
    s_barrier
    ds_read_b128 v[44:47], v2 offset:32768
    ds_read_b128 v[48:51], v2 offset:33792
    v_exp_f32 v68, v68
    v_exp_f32 v69, v69
    v_mfma_f32_32x32x16_bf16 v[164:179], v[64:67], v[144:147], v[164:179]
    ds_read_b128 v[60:63], v2 offset:34816
    ds_read_b128 v[64:67], v2 offset:35840
    v_exp_f32 v70, v70
    s_add_u32 m0, s41, 16384
    s_add_u32 s45, s40, 212992
    buffer_load_dwordx4 v1, s[20:23], s45 offen sc1 lds
    v_exp_f32 v71, v71
    v_cvt_pk_bf16_f32 v132, v68, v69
    v_cvt_pk_bf16_f32 v133, v70, v71
    v_mfma_f32_32x32x16_bf16 v[180:195], v[228:231], v[212:215], v[180:195]
    v_exp_f32 v72, v72
    v_exp_f32 v73, v73
    v_exp_f32 v74, v74
    v_exp_f32 v75, v75
    v_mfma_f32_32x32x16_bf16 v[196:211], v[228:231], v[216:219], v[196:211]
    buffer_load_dwordx4 v1, s[20:23], s45 offen offset:1024 sc1 lds
    v_cvt_pk_bf16_f32 v134, v72, v73
    ds_read_b64_tr_b16 v[228:229], v10 offset:0
    ds_read_b64_tr_b16 v[230:231], v10 offset:1024
    ds_read_b128 v[212:215], v4 offset:0
    ds_read_b128 v[216:219], v4 offset:8192
    v_cvt_pk_bf16_f32 v135, v74, v75
    v_exp_f32 v76, v76
    v_exp_f32 v77, v77
    v_mfma_f32_32x32x16_bf16 v[148:163], v[52:55], v[132:135], v[148:163]
    v_exp_f32 v78, v78
    v_exp_f32 v79, v79
    v_cvt_pk_bf16_f32 v136, v76, v77
    s_add_u32 m0, s43, 0
    s_nop 0
    buffer_load_dwordx4 v12, s[76:79], s42 offen offset:0 sc1 lds
    v_cvt_pk_bf16_f32 v137, v78, v79
    s_waitcnt lgkmcnt(7)
    v_mfma_f32_32x32x16_bf16 v[84:99], v[44:47], v[20:23], 0
    v_exp_f32 v80, v80
    v_exp_f32 v81, v81
    v_exp_f32 v82, v82
    v_exp_f32 v83, v83
    v_mfma_f32_32x32x16_bf16 v[180:195], v[232:235], v[220:223], v[180:195]
    v_cvt_pk_bf16_f32 v138, v80, v81
    v_cvt_pk_bf16_f32 v139, v82, v83
    buffer_load_dwordx4 v13, s[76:79], s42 offen offset:1024 sc1 lds
    v_exp_f32 v100, v100
    v_exp_f32 v101, v101
    v_mfma_f32_32x32x16_bf16 v[148:163], v[56:59], v[136:139], v[148:163]
    v_exp_f32 v102, v102
    v_exp_f32 v103, v103
    v_cvt_pk_bf16_f32 v140, v100, v101
    v_cvt_pk_bf16_f32 v141, v102, v103
    v_mfma_f32_32x32x16_bf16 v[196:211], v[232:235], v[224:227], v[196:211]
    v_exp_f32 v104, v104
    ds_read_b64_tr_b16 v[232:233], v10 offset:2048
    ds_read_b64_tr_b16 v[234:235], v10 offset:3072
    ds_read_b128 v[220:223], v4 offset:1024
    ds_read_b128 v[224:227], v4 offset:9216
    buffer_load_dwordx4 v14, s[76:79], s42 offen offset:2048 sc1 lds
    v_exp_f32 v105, v105
    v_exp_f32 v106, v106
    v_exp_f32 v107, v107
    s_waitcnt lgkmcnt(10)
    v_mfma_f32_32x32x16_bf16 v[84:99], v[48:51], v[24:27], v[84:99]
    v_cvt_pk_bf16_f32 v142, v104, v105
    v_cvt_pk_bf16_f32 v143, v106, v107
    v_exp_f32 v108, v108
    v_exp_f32 v109, v109
    v_mfma_f32_32x32x16_bf16 v[164:179], v[52:55], v[140:143], v[164:179]
    buffer_load_dwordx4 v15, s[76:79], s42 offen offset:3072 sc1 lds
    s_add_u32 s42, s42, s44
    v_exp_f32 v110, v110
    v_exp_f32 v111, v111
    v_cvt_pk_bf16_f32 v144, v108, v109
    v_cvt_pk_bf16_f32 v145, v110, v111
    v_mfma_f32_32x32x16_bf16 v[116:131], v[44:47], v[28:31], 0
    v_exp_f32 v112, v112
    v_exp_f32 v113, v113
    v_exp_f32 v114, v114
    v_exp_f32 v115, v115
    v_mfma_f32_32x32x16_bf16 v[116:131], v[48:51], v[32:35], v[116:131]
    v_cvt_pk_bf16_f32 v146, v112, v113
    v_cvt_pk_bf16_f32 v147, v114, v115
    s_waitcnt vmcnt(6) lgkmcnt(0)
    s_barrier
    ds_read_b128 v[36:39], v2 offset:0
    ds_read_b128 v[40:43], v2 offset:1024
    v_exp_f32 v84, v84
    v_exp_f32 v85, v85
    v_mfma_f32_32x32x16_bf16 v[164:179], v[56:59], v[144:147], v[164:179]
    ds_read_b128 v[52:55], v2 offset:2048
    ds_read_b128 v[56:59], v2 offset:3072
    v_exp_f32 v86, v86
    s_add_u32 m0, s41, 32768
    s_add_u32 s45, s40, 229376
    buffer_load_dwordx4 v1, s[20:23], s45 offen sc1 lds
    v_exp_f32 v87, v87
    v_cvt_pk_bf16_f32 v132, v84, v85
    v_cvt_pk_bf16_f32 v133, v86, v87
    v_mfma_f32_32x32x16_bf16 v[180:195], v[228:231], v[212:215], v[180:195]
    v_exp_f32 v88, v88
    v_exp_f32 v89, v89
    v_exp_f32 v90, v90
    v_exp_f32 v91, v91
    v_mfma_f32_32x32x16_bf16 v[196:211], v[228:231], v[216:219], v[196:211]
    buffer_load_dwordx4 v1, s[20:23], s45 offen offset:1024 sc1 lds
    v_cvt_pk_bf16_f32 v134, v88, v89
    ds_read_b64_tr_b16 v[228:229], v11 offset:0
    ds_read_b64_tr_b16 v[230:231], v11 offset:1024
    ds_read_b128 v[212:215], v8 offset:0
    ds_read_b128 v[216:219], v8 offset:8192
    v_cvt_pk_bf16_f32 v135, v90, v91
    v_exp_f32 v92, v92
    v_exp_f32 v93, v93
    v_mfma_f32_32x32x16_bf16 v[148:163], v[60:63], v[132:135], v[148:163]
    v_exp_f32 v94, v94
    v_exp_f32 v95, v95
    v_cvt_pk_bf16_f32 v136, v92, v93
    s_add_u32 m0, s43, 32768
    s_nop 0
    buffer_load_dwordx4 v12, s[76:79], s42 offen offset:0 sc1 lds
    v_cvt_pk_bf16_f32 v137, v94, v95
    s_waitcnt lgkmcnt(7)
    v_mfma_f32_32x32x16_bf16 v[68:83], v[36:39], v[20:23], 0
    v_exp_f32 v96, v96
    v_exp_f32 v97, v97
    v_exp_f32 v98, v98
    v_exp_f32 v99, v99
    v_mfma_f32_32x32x16_bf16 v[180:195], v[232:235], v[220:223], v[180:195]
    v_cvt_pk_bf16_f32 v138, v96, v97
    v_cvt_pk_bf16_f32 v139, v98, v99
    buffer_load_dwordx4 v13, s[76:79], s42 offen offset:1024 sc1 lds
    v_exp_f32 v116, v116
    v_exp_f32 v117, v117
    v_mfma_f32_32x32x16_bf16 v[148:163], v[64:67], v[136:139], v[148:163]
    v_exp_f32 v118, v118
    v_exp_f32 v119, v119
    v_cvt_pk_bf16_f32 v140, v116, v117
    v_cvt_pk_bf16_f32 v141, v118, v119
    v_mfma_f32_32x32x16_bf16 v[196:211], v[232:235], v[224:227], v[196:211]
    v_exp_f32 v120, v120
    ds_read_b64_tr_b16 v[232:233], v11 offset:2048
    ds_read_b64_tr_b16 v[234:235], v11 offset:3072
    ds_read_b128 v[220:223], v8 offset:1024
    ds_read_b128 v[224:227], v8 offset:9216
    buffer_load_dwordx4 v14, s[76:79], s42 offen offset:2048 sc1 lds
    v_exp_f32 v121, v121
    v_exp_f32 v122, v122
    v_exp_f32 v123, v123
    s_waitcnt lgkmcnt(10)
    v_mfma_f32_32x32x16_bf16 v[68:83], v[40:43], v[24:27], v[68:83]
    v_cvt_pk_bf16_f32 v142, v120, v121
    v_cvt_pk_bf16_f32 v143, v122, v123
    v_exp_f32 v124, v124
    v_exp_f32 v125, v125
    v_mfma_f32_32x32x16_bf16 v[164:179], v[60:63], v[140:143], v[164:179]
    buffer_load_dwordx4 v15, s[76:79], s42 offen offset:3072 sc1 lds
    s_add_u32 s42, s42, s44
    v_exp_f32 v126, v126
    v_exp_f32 v127, v127
    v_cvt_pk_bf16_f32 v144, v124, v125
    v_cvt_pk_bf16_f32 v145, v126, v127
    v_mfma_f32_32x32x16_bf16 v[100:115], v[36:39], v[28:31], 0
    v_exp_f32 v128, v128
    v_exp_f32 v129, v129
    v_exp_f32 v130, v130
    v_exp_f32 v131, v131
    v_mfma_f32_32x32x16_bf16 v[100:115], v[40:43], v[32:35], v[100:115]
    v_cvt_pk_bf16_f32 v146, v128, v129
    v_cvt_pk_bf16_f32 v147, v130, v131
    s_waitcnt vmcnt(6) lgkmcnt(0)
    s_barrier
    ds_read_b128 v[44:47], v2 offset:16384
    ds_read_b128 v[48:51], v2 offset:17408
    v_exp_f32 v68, v68
    v_exp_f32 v69, v69
    v_mfma_f32_32x32x16_bf16 v[164:179], v[64:67], v[144:147], v[164:179]
    ds_read_b128 v[60:63], v2 offset:18432
    ds_read_b128 v[64:67], v2 offset:19456
    v_exp_f32 v70, v70
    s_add_u32 m0, s41, 0
    s_add_u32 s45, s40, 245760
    buffer_load_dwordx4 v1, s[20:23], s45 offen sc1 lds
    v_exp_f32 v71, v71
    v_cvt_pk_bf16_f32 v132, v68, v69
    v_cvt_pk_bf16_f32 v133, v70, v71
    v_mfma_f32_32x32x16_bf16 v[180:195], v[228:231], v[212:215], v[180:195]
    v_exp_f32 v72, v72
    v_exp_f32 v73, v73
    v_exp_f32 v74, v74
    v_exp_f32 v75, v75
    v_mfma_f32_32x32x16_bf16 v[196:211], v[228:231], v[216:219], v[196:211]
    buffer_load_dwordx4 v1, s[20:23], s45 offen offset:1024 sc1 lds
    v_cvt_pk_bf16_f32 v134, v72, v73
    ds_read_b64_tr_b16 v[228:229], v9 offset:0
    ds_read_b64_tr_b16 v[230:231], v9 offset:1024
    ds_read_b128 v[212:215], v3 offset:0
    ds_read_b128 v[216:219], v3 offset:8192
    v_cvt_pk_bf16_f32 v135, v74, v75
    v_exp_f32 v76, v76
    v_exp_f32 v77, v77
    v_mfma_f32_32x32x16_bf16 v[148:163], v[52:55], v[132:135], v[148:163]
    v_exp_f32 v78, v78
    v_exp_f32 v79, v79
    v_cvt_pk_bf16_f32 v136, v76, v77
    s_add_u32 m0, s43, 65536
    s_nop 0
    buffer_load_dwordx4 v12, s[76:79], s42 offen offset:0 sc1 lds
    v_cvt_pk_bf16_f32 v137, v78, v79
    s_waitcnt lgkmcnt(7)
    v_mfma_f32_32x32x16_bf16 v[84:99], v[44:47], v[20:23], 0
    v_exp_f32 v80, v80
    v_exp_f32 v81, v81
    v_exp_f32 v82, v82
    v_exp_f32 v83, v83
    v_mfma_f32_32x32x16_bf16 v[180:195], v[232:235], v[220:223], v[180:195]
    v_cvt_pk_bf16_f32 v138, v80, v81
    v_cvt_pk_bf16_f32 v139, v82, v83
    buffer_load_dwordx4 v13, s[76:79], s42 offen offset:1024 sc1 lds
    v_exp_f32 v100, v100
    v_exp_f32 v101, v101
    v_mfma_f32_32x32x16_bf16 v[148:163], v[56:59], v[136:139], v[148:163]
    v_exp_f32 v102, v102
    v_exp_f32 v103, v103
    v_cvt_pk_bf16_f32 v140, v100, v101
    v_cvt_pk_bf16_f32 v141, v102, v103
    v_mfma_f32_32x32x16_bf16 v[196:211], v[232:235], v[224:227], v[196:211]
    v_exp_f32 v104, v104
    ds_read_b64_tr_b16 v[232:233], v9 offset:2048
    ds_read_b64_tr_b16 v[234:235], v9 offset:3072
    ds_read_b128 v[220:223], v3 offset:1024
    ds_read_b128 v[224:227], v3 offset:9216
    buffer_load_dwordx4 v14, s[76:79], s42 offen offset:2048 sc1 lds
    v_exp_f32 v105, v105
    v_exp_f32 v106, v106
    v_exp_f32 v107, v107
    s_waitcnt lgkmcnt(10)
    v_mfma_f32_32x32x16_bf16 v[84:99], v[48:51], v[24:27], v[84:99]
    v_cvt_pk_bf16_f32 v142, v104, v105
    v_cvt_pk_bf16_f32 v143, v106, v107
    v_exp_f32 v108, v108
    v_exp_f32 v109, v109
    v_mfma_f32_32x32x16_bf16 v[164:179], v[52:55], v[140:143], v[164:179]
    buffer_load_dwordx4 v15, s[76:79], s42 offen offset:3072 sc1 lds
    s_add_u32 s42, s42, s44
    v_exp_f32 v110, v110
    v_exp_f32 v111, v111
    v_cvt_pk_bf16_f32 v144, v108, v109
    v_cvt_pk_bf16_f32 v145, v110, v111
    v_mfma_f32_32x32x16_bf16 v[116:131], v[44:47], v[28:31], 0
    v_exp_f32 v112, v112
    v_exp_f32 v113, v113
    v_exp_f32 v114, v114
    v_exp_f32 v115, v115
    v_mfma_f32_32x32x16_bf16 v[116:131], v[48:51], v[32:35], v[116:131]
    v_cvt_pk_bf16_f32 v146, v112, v113
    v_cvt_pk_bf16_f32 v147, v114, v115
    s_waitcnt vmcnt(6) lgkmcnt(0)
    s_barrier
    ds_read_b128 v[36:39], v2 offset:32768
    ds_read_b128 v[40:43], v2 offset:33792
    v_exp_f32 v84, v84
    v_exp_f32 v85, v85
    v_mfma_f32_32x32x16_bf16 v[164:179], v[56:59], v[144:147], v[164:179]
    ds_read_b128 v[52:55], v2 offset:34816
    ds_read_b128 v[56:59], v2 offset:35840
    v_exp_f32 v86, v86
    s_add_u32 m0, s43, 0
    s_nop 0
    buffer_load_dwordx4 v12, s[76:79], s42 offen offset:0 sc1 lds
    v_exp_f32 v87, v87
    v_cvt_pk_bf16_f32 v132, v84, v85
    v_cvt_pk_bf16_f32 v133, v86, v87
    v_mfma_f32_32x32x16_bf16 v[180:195], v[228:231], v[212:215], v[180:195]
    v_exp_f32 v88, v88
    v_exp_f32 v89, v89
    v_exp_f32 v90, v90
    v_exp_f32 v91, v91
    v_mfma_f32_32x32x16_bf16 v[196:211], v[228:231], v[216:219], v[196:211]
    buffer_load_dwordx4 v13, s[76:79], s42 offen offset:1024 sc1 lds
    v_cvt_pk_bf16_f32 v134, v88, v89
    ds_read_b64_tr_b16 v[228:229], v10 offset:0
    ds_read_b64_tr_b16 v[230:231], v10 offset:1024
    ds_read_b128 v[212:215], v4 offset:0
    ds_read_b128 v[216:219], v4 offset:8192
    v_cvt_pk_bf16_f32 v135, v90, v91
    v_exp_f32 v92, v92
    v_exp_f32 v93, v93
    v_mfma_f32_32x32x16_bf16 v[148:163], v[60:63], v[132:135], v[148:163]
    v_exp_f32 v94, v94
    v_exp_f32 v95, v95
    v_cvt_pk_bf16_f32 v136, v92, v93
    buffer_load_dwordx4 v14, s[76:79], s42 offen offset:2048 sc1 lds
    v_cvt_pk_bf16_f32 v137, v94, v95
    s_waitcnt lgkmcnt(7)
    v_mfma_f32_32x32x16_bf16 v[68:83], v[36:39], v[20:23], 0
    v_exp_f32 v96, v96
    v_exp_f32 v97, v97
    v_exp_f32 v98, v98
    v_exp_f32 v99, v99
    v_mfma_f32_32x32x16_bf16 v[180:195], v[232:235], v[220:223], v[180:195]
    v_cvt_pk_bf16_f32 v138, v96, v97
    v_cvt_pk_bf16_f32 v139, v98, v99
    buffer_load_dwordx4 v15, s[76:79], s42 offen offset:3072 sc1 lds
    s_add_u32 s42, s42, s44
    v_exp_f32 v116, v116
    v_exp_f32 v117, v117
    v_mfma_f32_32x32x16_bf16 v[148:163], v[64:67], v[136:139], v[148:163]
    v_exp_f32 v118, v118
    v_exp_f32 v119, v119
    v_cvt_pk_bf16_f32 v140, v116, v117
    v_cvt_pk_bf16_f32 v141, v118, v119
    v_mfma_f32_32x32x16_bf16 v[196:211], v[232:235], v[224:227], v[196:211]
    v_exp_f32 v120, v120
    ds_read_b64_tr_b16 v[232:233], v10 offset:2048
    ds_read_b64_tr_b16 v[234:235], v10 offset:3072
    ds_read_b128 v[220:223], v4 offset:1024
    ds_read_b128 v[224:227], v4 offset:9216
    v_exp_f32 v121, v121
    v_exp_f32 v122, v122
    v_exp_f32 v123, v123
    s_waitcnt lgkmcnt(10)
    v_mfma_f32_32x32x16_bf16 v[68:83], v[40:43], v[24:27], v[68:83]
    v_cvt_pk_bf16_f32 v142, v120, v121
    v_cvt_pk_bf16_f32 v143, v122, v123
    v_exp_f32 v124, v124
    v_exp_f32 v125, v125
    v_mfma_f32_32x32x16_bf16 v[164:179], v[60:63], v[140:143], v[164:179]
    v_exp_f32 v126, v126
    v_exp_f32 v127, v127
    v_cvt_pk_bf16_f32 v144, v124, v125
    v_cvt_pk_bf16_f32 v145, v126, v127
    v_mfma_f32_32x32x16_bf16 v[100:115], v[36:39], v[28:31], 0
    v_exp_f32 v128, v128
    v_exp_f32 v129, v129
    v_exp_f32 v130, v130
    v_exp_f32 v131, v131
    v_mfma_f32_32x32x16_bf16 v[100:115], v[40:43], v[32:35], v[100:115]
    v_cvt_pk_bf16_f32 v146, v128, v129
    v_cvt_pk_bf16_f32 v147, v130, v131
    s_waitcnt vmcnt(8) lgkmcnt(0)
    s_barrier
    ds_read_b128 v[44:47], v2 offset:0
    ds_read_b128 v[48:51], v2 offset:1024
    v_exp_f32 v68, v68
    v_exp_f32 v69, v69
    v_mfma_f32_32x32x16_bf16 v[164:179], v[64:67], v[144:147], v[164:179]
    ds_read_b128 v[60:63], v2 offset:2048
    ds_read_b128 v[64:67], v2 offset:3072
    v_exp_f32 v70, v70
    s_add_u32 m0, s43, 32768
    s_nop 0
    buffer_load_dwordx4 v12, s[76:79], s42 offen offset:0 sc1 lds
    v_exp_f32 v71, v71
    v_cvt_pk_bf16_f32 v132, v68, v69
    v_cvt_pk_bf16_f32 v133, v70, v71
    v_mfma_f32_32x32x16_bf16 v[180:195], v[228:231], v[212:215], v[180:195]
    v_exp_f32 v72, v72
    v_exp_f32 v73, v73
    v_exp_f32 v74, v74
    v_exp_f32 v75, v75
    v_mfma_f32_32x32x16_bf16 v[196:211], v[228:231], v[216:219], v[196:211]
    buffer_load_dwordx4 v13, s[76:79], s42 offen offset:1024 sc1 lds
    v_cvt_pk_bf16_f32 v134, v72, v73
    v_cvt_pk_bf16_f32 v135, v74, v75
    v_exp_f32 v76, v76
    v_exp_f32 v77, v77
    v_mfma_f32_32x32x16_bf16 v[148:163], v[52:55], v[132:135], v[148:163]
    v_exp_f32 v78, v78
    v_exp_f32 v79, v79
    v_cvt_pk_bf16_f32 v136, v76, v77
    buffer_load_dwordx4 v14, s[76:79], s42 offen offset:2048 sc1 lds
    v_cvt_pk_bf16_f32 v137, v78, v79
    s_waitcnt lgkmcnt(3)
    v_mfma_f32_32x32x16_bf16 v[84:99], v[44:47], v[20:23], 0
    v_exp_f32 v80, v80
    v_exp_f32 v81, v81
    v_exp_f32 v82, v82
    v_exp_f32 v83, v83
    v_mfma_f32_32x32x16_bf16 v[180:195], v[232:235], v[220:223], v[180:195]
    v_cvt_pk_bf16_f32 v138, v80, v81
    v_cvt_pk_bf16_f32 v139, v82, v83
    buffer_load_dwordx4 v15, s[76:79], s42 offen offset:3072 sc1 lds
    s_add_u32 s42, s42, s44
    v_exp_f32 v100, v100
    v_exp_f32 v101, v101
    v_mfma_f32_32x32x16_bf16 v[148:163], v[56:59], v[136:139], v[148:163]
    v_exp_f32 v102, v102
    v_exp_f32 v103, v103
    v_cvt_pk_bf16_f32 v140, v100, v101
    v_cvt_pk_bf16_f32 v141, v102, v103
    v_mfma_f32_32x32x16_bf16 v[196:211], v[232:235], v[224:227], v[196:211]
    v_exp_f32 v104, v104
    v_exp_f32 v105, v105
    v_exp_f32 v106, v106
    v_exp_f32 v107, v107
    s_waitcnt lgkmcnt(2)
    v_mfma_f32_32x32x16_bf16 v[84:99], v[48:51], v[24:27], v[84:99]
    v_cvt_pk_bf16_f32 v142, v104, v105
    v_cvt_pk_bf16_f32 v143, v106, v107
    v_exp_f32 v108, v108
    v_exp_f32 v109, v109
    v_mfma_f32_32x32x16_bf16 v[164:179], v[52:55], v[140:143], v[164:179]
    v_exp_f32 v110, v110
    v_exp_f32 v111, v111
    v_cvt_pk_bf16_f32 v144, v108, v109
    v_cvt_pk_bf16_f32 v145, v110, v111
    v_mfma_f32_32x32x16_bf16 v[116:131], v[44:47], v[28:31], 0
    v_exp_f32 v112, v112
    v_exp_f32 v113, v113
    v_exp_f32 v114, v114
    v_exp_f32 v115, v115
    v_mfma_f32_32x32x16_bf16 v[116:131], v[48:51], v[32:35], v[116:131]
    v_cvt_pk_bf16_f32 v146, v112, v113
    v_cvt_pk_bf16_f32 v147, v114, v115
    s_waitcnt lgkmcnt(0)
    s_barrier
    v_exp_f32 v84, v84
    v_exp_f32 v85, v85
    v_mfma_f32_32x32x16_bf16 v[164:179], v[56:59], v[144:147], v[164:179]
    v_exp_f32 v86, v86
    v_exp_f32 v87, v87
    v_cvt_pk_bf16_f32 v132, v84, v85
    v_cvt_pk_bf16_f32 v133, v86, v87
    v_exp_f32 v88, v88
    v_exp_f32 v89, v89
    v_exp_f32 v90, v90
    v_exp_f32 v91, v91
    v_cvt_pk_bf16_f32 v134, v88, v89
    v_cvt_pk_bf16_f32 v135, v90, v91
    v_exp_f32 v92, v92
    v_exp_f32 v93, v93
    v_mfma_f32_32x32x16_bf16 v[148:163], v[60:63], v[132:135], v[148:163]
    v_exp_f32 v94, v94
    v_exp_f32 v95, v95
    v_cvt_pk_bf16_f32 v136, v92, v93
    v_cvt_pk_bf16_f32 v137, v94, v95
    v_exp_f32 v96, v96
    v_exp_f32 v97, v97
    v_exp_f32 v98, v98
    v_exp_f32 v99, v99
    v_cvt_pk_bf16_f32 v138, v96, v97
    v_cvt_pk_bf16_f32 v139, v98, v99
    v_exp_f32 v116, v116
    v_exp_f32 v117, v117
    v_mfma_f32_32x32x16_bf16 v[148:163], v[64:67], v[136:139], v[148:163]
    v_exp_f32 v118, v118
    v_exp_f32 v119, v119
    v_cvt_pk_bf16_f32 v140, v116, v117
    v_cvt_pk_bf16_f32 v141, v118, v119
    v_exp_f32 v120, v120
    v_exp_f32 v121, v121
    v_exp_f32 v122, v122
    v_exp_f32 v123, v123
    v_cvt_pk_bf16_f32 v142, v120, v121
    v_cvt_pk_bf16_f32 v143, v122, v123
    v_exp_f32 v124, v124
    v_exp_f32 v125, v125
    v_mfma_f32_32x32x16_bf16 v[164:179], v[60:63], v[140:143], v[164:179]
    v_exp_f32 v126, v126
    v_exp_f32 v127, v127
    v_cvt_pk_bf16_f32 v144, v124, v125
    v_cvt_pk_bf16_f32 v145, v126, v127
    v_exp_f32 v128, v128
    v_exp_f32 v129, v129
    v_exp_f32 v130, v130
    v_exp_f32 v131, v131
    v_cvt_pk_bf16_f32 v146, v128, v129
    v_cvt_pk_bf16_f32 v147, v130, v131
    s_nop 1
    v_mfma_f32_32x32x16_bf16 v[164:179], v[64:67], v[144:147], v[164:179]
    s_branch parallel_sum__softmax_full_mha__swiglu_ffn__prompt_kernel_b_tail
parallel_sum__softmax_full_mha__swiglu_ffn__prompt_kernel_b_loop_n:
    s_waitcnt vmcnt(2) lgkmcnt(0)
    s_barrier
    ds_read_b128 v[44:47], v2 offset:16384
    ds_read_b128 v[48:51], v2 offset:17408
    v_exp_f32 v68, v68
    v_exp_f32 v69, v69
    ds_read_b128 v[60:63], v2 offset:18432
    ds_read_b128 v[64:67], v2 offset:19456
    v_exp_f32 v70, v70
    s_add_u32 m0, s41, 0
    s_add_u32 s45, s40, 49152
    buffer_load_dwordx4 v1, s[20:23], s45 offen sc1 lds
    v_exp_f32 v71, v71
    v_cvt_pk_bf16_f32 v132, v68, v69
    v_cvt_pk_bf16_f32 v133, v70, v71
    v_exp_f32 v72, v72
    v_exp_f32 v73, v73
    v_exp_f32 v74, v74
    v_exp_f32 v75, v75
    buffer_load_dwordx4 v1, s[20:23], s45 offen offset:1024 sc1 lds
    v_cvt_pk_bf16_f32 v134, v72, v73
    v_cvt_pk_bf16_f32 v135, v74, v75
    v_exp_f32 v76, v76
    v_exp_f32 v77, v77
    v_mfma_f32_32x32x16_bf16 v[148:163], v[52:55], v[132:135], 0
    v_exp_f32 v78, v78
    v_exp_f32 v79, v79
    v_cvt_pk_bf16_f32 v136, v76, v77
    v_cvt_pk_bf16_f32 v137, v78, v79
    s_waitcnt lgkmcnt(3)
    v_mfma_f32_32x32x16_bf16 v[84:99], v[44:47], v[20:23], 0
    v_exp_f32 v80, v80
    v_exp_f32 v81, v81
    v_exp_f32 v82, v82
    v_exp_f32 v83, v83
    v_cvt_pk_bf16_f32 v138, v80, v81
    v_cvt_pk_bf16_f32 v139, v82, v83
    v_exp_f32 v100, v100
    v_exp_f32 v101, v101
    v_mfma_f32_32x32x16_bf16 v[148:163], v[56:59], v[136:139], v[148:163]
    v_exp_f32 v102, v102
    v_exp_f32 v103, v103
    v_cvt_pk_bf16_f32 v140, v100, v101
    v_cvt_pk_bf16_f32 v141, v102, v103
    v_exp_f32 v104, v104
    v_exp_f32 v105, v105
    v_exp_f32 v106, v106
    v_exp_f32 v107, v107
    s_waitcnt lgkmcnt(2)
    v_mfma_f32_32x32x16_bf16 v[84:99], v[48:51], v[24:27], v[84:99]
    v_cvt_pk_bf16_f32 v142, v104, v105
    v_cvt_pk_bf16_f32 v143, v106, v107
    v_exp_f32 v108, v108
    v_exp_f32 v109, v109
    v_mfma_f32_32x32x16_bf16 v[164:179], v[52:55], v[140:143], 0
    v_exp_f32 v110, v110
    v_exp_f32 v111, v111
    v_cvt_pk_bf16_f32 v144, v108, v109
    v_cvt_pk_bf16_f32 v145, v110, v111
    v_mfma_f32_32x32x16_bf16 v[116:131], v[44:47], v[28:31], 0
    v_exp_f32 v112, v112
    v_exp_f32 v113, v113
    v_exp_f32 v114, v114
    v_exp_f32 v115, v115
    v_mfma_f32_32x32x16_bf16 v[116:131], v[48:51], v[32:35], v[116:131]
    v_cvt_pk_bf16_f32 v146, v112, v113
    v_cvt_pk_bf16_f32 v147, v114, v115
    s_waitcnt vmcnt(2) lgkmcnt(0)
    s_barrier
    ds_read_b128 v[36:39], v2 offset:32768
    ds_read_b128 v[40:43], v2 offset:33792
    v_exp_f32 v84, v84
    v_exp_f32 v85, v85
    v_mfma_f32_32x32x16_bf16 v[164:179], v[56:59], v[144:147], v[164:179]
    ds_read_b128 v[52:55], v2 offset:34816
    ds_read_b128 v[56:59], v2 offset:35840
    v_exp_f32 v86, v86
    s_add_u32 m0, s41, 16384
    s_add_u32 s45, s40, 65536
    buffer_load_dwordx4 v1, s[20:23], s45 offen sc1 lds
    v_exp_f32 v87, v87
    v_cvt_pk_bf16_f32 v132, v84, v85
    v_cvt_pk_bf16_f32 v133, v86, v87
    v_exp_f32 v88, v88
    v_exp_f32 v89, v89
    v_exp_f32 v90, v90
    v_exp_f32 v91, v91
    buffer_load_dwordx4 v1, s[20:23], s45 offen offset:1024 sc1 lds
    v_cvt_pk_bf16_f32 v134, v88, v89
    v_cvt_pk_bf16_f32 v135, v90, v91
    v_exp_f32 v92, v92
    v_exp_f32 v93, v93
    v_mfma_f32_32x32x16_bf16 v[148:163], v[60:63], v[132:135], v[148:163]
    v_exp_f32 v94, v94
    v_exp_f32 v95, v95
    v_cvt_pk_bf16_f32 v136, v92, v93
    v_cvt_pk_bf16_f32 v137, v94, v95
    s_waitcnt lgkmcnt(3)
    v_mfma_f32_32x32x16_bf16 v[68:83], v[36:39], v[20:23], 0
    v_exp_f32 v96, v96
    v_exp_f32 v97, v97
    v_exp_f32 v98, v98
    v_exp_f32 v99, v99
    v_cvt_pk_bf16_f32 v138, v96, v97
    v_cvt_pk_bf16_f32 v139, v98, v99
    v_exp_f32 v116, v116
    v_exp_f32 v117, v117
    v_mfma_f32_32x32x16_bf16 v[148:163], v[64:67], v[136:139], v[148:163]
    v_exp_f32 v118, v118
    v_exp_f32 v119, v119
    v_cvt_pk_bf16_f32 v140, v116, v117
    v_cvt_pk_bf16_f32 v141, v118, v119
    v_exp_f32 v120, v120
    v_exp_f32 v121, v121
    v_exp_f32 v122, v122
    v_exp_f32 v123, v123
    s_waitcnt lgkmcnt(2)
    v_mfma_f32_32x32x16_bf16 v[68:83], v[40:43], v[24:27], v[68:83]
    v_cvt_pk_bf16_f32 v142, v120, v121
    v_cvt_pk_bf16_f32 v143, v122, v123
    v_exp_f32 v124, v124
    v_exp_f32 v125, v125
    v_mfma_f32_32x32x16_bf16 v[164:179], v[60:63], v[140:143], v[164:179]
    v_exp_f32 v126, v126
    v_exp_f32 v127, v127
    v_cvt_pk_bf16_f32 v144, v124, v125
    v_cvt_pk_bf16_f32 v145, v126, v127
    v_mfma_f32_32x32x16_bf16 v[100:115], v[36:39], v[28:31], 0
    v_exp_f32 v128, v128
    v_exp_f32 v129, v129
    v_exp_f32 v130, v130
    v_exp_f32 v131, v131
    v_mfma_f32_32x32x16_bf16 v[100:115], v[40:43], v[32:35], v[100:115]
    v_cvt_pk_bf16_f32 v146, v128, v129
    v_cvt_pk_bf16_f32 v147, v130, v131
    s_waitcnt vmcnt(2) lgkmcnt(0)
    s_barrier
    ds_read_b128 v[44:47], v2 offset:0
    ds_read_b128 v[48:51], v2 offset:1024
    v_exp_f32 v68, v68
    v_exp_f32 v69, v69
    v_mfma_f32_32x32x16_bf16 v[164:179], v[64:67], v[144:147], v[164:179]
    ds_read_b128 v[60:63], v2 offset:2048
    ds_read_b128 v[64:67], v2 offset:3072
    v_exp_f32 v70, v70
    s_add_u32 m0, s41, 32768
    s_add_u32 s45, s40, 81920
    buffer_load_dwordx4 v1, s[20:23], s45 offen sc1 lds
    v_exp_f32 v71, v71
    v_cvt_pk_bf16_f32 v132, v68, v69
    v_cvt_pk_bf16_f32 v133, v70, v71
    v_exp_f32 v72, v72
    v_exp_f32 v73, v73
    v_exp_f32 v74, v74
    v_exp_f32 v75, v75
    buffer_load_dwordx4 v1, s[20:23], s45 offen offset:1024 sc1 lds
    v_cvt_pk_bf16_f32 v134, v72, v73
    v_cvt_pk_bf16_f32 v135, v74, v75
    v_exp_f32 v76, v76
    v_exp_f32 v77, v77
    v_mfma_f32_32x32x16_bf16 v[148:163], v[52:55], v[132:135], v[148:163]
    v_exp_f32 v78, v78
    v_exp_f32 v79, v79
    v_cvt_pk_bf16_f32 v136, v76, v77
    v_cvt_pk_bf16_f32 v137, v78, v79
    s_waitcnt lgkmcnt(3)
    v_mfma_f32_32x32x16_bf16 v[84:99], v[44:47], v[20:23], 0
    v_exp_f32 v80, v80
    v_exp_f32 v81, v81
    v_exp_f32 v82, v82
    v_exp_f32 v83, v83
    v_cvt_pk_bf16_f32 v138, v80, v81
    v_cvt_pk_bf16_f32 v139, v82, v83
    v_exp_f32 v100, v100
    v_exp_f32 v101, v101
    v_mfma_f32_32x32x16_bf16 v[148:163], v[56:59], v[136:139], v[148:163]
    v_exp_f32 v102, v102
    v_exp_f32 v103, v103
    v_cvt_pk_bf16_f32 v140, v100, v101
    v_cvt_pk_bf16_f32 v141, v102, v103
    v_exp_f32 v104, v104
    v_exp_f32 v105, v105
    v_exp_f32 v106, v106
    v_exp_f32 v107, v107
    s_waitcnt lgkmcnt(2)
    v_mfma_f32_32x32x16_bf16 v[84:99], v[48:51], v[24:27], v[84:99]
    v_cvt_pk_bf16_f32 v142, v104, v105
    v_cvt_pk_bf16_f32 v143, v106, v107
    v_exp_f32 v108, v108
    v_exp_f32 v109, v109
    v_mfma_f32_32x32x16_bf16 v[164:179], v[52:55], v[140:143], v[164:179]
    v_exp_f32 v110, v110
    v_exp_f32 v111, v111
    v_cvt_pk_bf16_f32 v144, v108, v109
    v_cvt_pk_bf16_f32 v145, v110, v111
    v_mfma_f32_32x32x16_bf16 v[116:131], v[44:47], v[28:31], 0
    v_exp_f32 v112, v112
    v_exp_f32 v113, v113
    v_exp_f32 v114, v114
    v_exp_f32 v115, v115
    v_mfma_f32_32x32x16_bf16 v[116:131], v[48:51], v[32:35], v[116:131]
    v_cvt_pk_bf16_f32 v146, v112, v113
    v_cvt_pk_bf16_f32 v147, v114, v115
    s_waitcnt vmcnt(2) lgkmcnt(0)
    s_barrier
    ds_read_b128 v[36:39], v2 offset:16384
    ds_read_b128 v[40:43], v2 offset:17408
    v_exp_f32 v84, v84
    v_exp_f32 v85, v85
    v_mfma_f32_32x32x16_bf16 v[164:179], v[56:59], v[144:147], v[164:179]
    ds_read_b128 v[52:55], v2 offset:18432
    ds_read_b128 v[56:59], v2 offset:19456
    v_exp_f32 v86, v86
    s_add_u32 m0, s41, 0
    s_add_u32 s45, s40, 98304
    buffer_load_dwordx4 v1, s[20:23], s45 offen sc1 lds
    v_exp_f32 v87, v87
    v_cvt_pk_bf16_f32 v132, v84, v85
    v_cvt_pk_bf16_f32 v133, v86, v87
    v_exp_f32 v88, v88
    v_exp_f32 v89, v89
    v_exp_f32 v90, v90
    v_exp_f32 v91, v91
    buffer_load_dwordx4 v1, s[20:23], s45 offen offset:1024 sc1 lds
    v_cvt_pk_bf16_f32 v134, v88, v89
    v_cvt_pk_bf16_f32 v135, v90, v91
    v_exp_f32 v92, v92
    v_exp_f32 v93, v93
    v_mfma_f32_32x32x16_bf16 v[148:163], v[60:63], v[132:135], v[148:163]
    v_exp_f32 v94, v94
    v_exp_f32 v95, v95
    v_cvt_pk_bf16_f32 v136, v92, v93
    v_cvt_pk_bf16_f32 v137, v94, v95
    s_waitcnt lgkmcnt(3)
    v_mfma_f32_32x32x16_bf16 v[68:83], v[36:39], v[20:23], 0
    v_exp_f32 v96, v96
    v_exp_f32 v97, v97
    v_exp_f32 v98, v98
    v_exp_f32 v99, v99
    v_cvt_pk_bf16_f32 v138, v96, v97
    v_cvt_pk_bf16_f32 v139, v98, v99
    v_exp_f32 v116, v116
    v_exp_f32 v117, v117
    v_mfma_f32_32x32x16_bf16 v[148:163], v[64:67], v[136:139], v[148:163]
    v_exp_f32 v118, v118
    v_exp_f32 v119, v119
    v_cvt_pk_bf16_f32 v140, v116, v117
    v_cvt_pk_bf16_f32 v141, v118, v119
    v_exp_f32 v120, v120
    v_exp_f32 v121, v121
    v_exp_f32 v122, v122
    v_exp_f32 v123, v123
    s_waitcnt lgkmcnt(2)
    v_mfma_f32_32x32x16_bf16 v[68:83], v[40:43], v[24:27], v[68:83]
    v_cvt_pk_bf16_f32 v142, v120, v121
    v_cvt_pk_bf16_f32 v143, v122, v123
    v_exp_f32 v124, v124
    v_exp_f32 v125, v125
    v_mfma_f32_32x32x16_bf16 v[164:179], v[60:63], v[140:143], v[164:179]
    v_exp_f32 v126, v126
    v_exp_f32 v127, v127
    v_cvt_pk_bf16_f32 v144, v124, v125
    v_cvt_pk_bf16_f32 v145, v126, v127
    v_mfma_f32_32x32x16_bf16 v[100:115], v[36:39], v[28:31], 0
    v_exp_f32 v128, v128
    v_exp_f32 v129, v129
    v_exp_f32 v130, v130
    v_exp_f32 v131, v131
    v_mfma_f32_32x32x16_bf16 v[100:115], v[40:43], v[32:35], v[100:115]
    v_cvt_pk_bf16_f32 v146, v128, v129
    v_cvt_pk_bf16_f32 v147, v130, v131
    s_waitcnt vmcnt(2) lgkmcnt(0)
    s_barrier
    ds_read_b128 v[44:47], v2 offset:32768
    ds_read_b128 v[48:51], v2 offset:33792
    v_exp_f32 v68, v68
    v_exp_f32 v69, v69
    v_mfma_f32_32x32x16_bf16 v[164:179], v[64:67], v[144:147], v[164:179]
    ds_read_b128 v[60:63], v2 offset:34816
    ds_read_b128 v[64:67], v2 offset:35840
    v_exp_f32 v70, v70
    s_add_u32 m0, s41, 16384
    s_add_u32 s45, s40, 114688
    buffer_load_dwordx4 v1, s[20:23], s45 offen sc1 lds
    v_exp_f32 v71, v71
    v_cvt_pk_bf16_f32 v132, v68, v69
    v_cvt_pk_bf16_f32 v133, v70, v71
    v_exp_f32 v72, v72
    v_exp_f32 v73, v73
    v_exp_f32 v74, v74
    v_exp_f32 v75, v75
    buffer_load_dwordx4 v1, s[20:23], s45 offen offset:1024 sc1 lds
    v_cvt_pk_bf16_f32 v134, v72, v73
    v_cvt_pk_bf16_f32 v135, v74, v75
    v_exp_f32 v76, v76
    v_exp_f32 v77, v77
    v_mfma_f32_32x32x16_bf16 v[148:163], v[52:55], v[132:135], v[148:163]
    v_exp_f32 v78, v78
    v_exp_f32 v79, v79
    v_cvt_pk_bf16_f32 v136, v76, v77
    v_cvt_pk_bf16_f32 v137, v78, v79
    s_waitcnt lgkmcnt(3)
    v_mfma_f32_32x32x16_bf16 v[84:99], v[44:47], v[20:23], 0
    v_exp_f32 v80, v80
    v_exp_f32 v81, v81
    v_exp_f32 v82, v82
    v_exp_f32 v83, v83
    v_cvt_pk_bf16_f32 v138, v80, v81
    v_cvt_pk_bf16_f32 v139, v82, v83
    v_exp_f32 v100, v100
    v_exp_f32 v101, v101
    v_mfma_f32_32x32x16_bf16 v[148:163], v[56:59], v[136:139], v[148:163]
    v_exp_f32 v102, v102
    v_exp_f32 v103, v103
    v_cvt_pk_bf16_f32 v140, v100, v101
    v_cvt_pk_bf16_f32 v141, v102, v103
    v_exp_f32 v104, v104
    v_exp_f32 v105, v105
    v_exp_f32 v106, v106
    v_exp_f32 v107, v107
    s_waitcnt lgkmcnt(2)
    v_mfma_f32_32x32x16_bf16 v[84:99], v[48:51], v[24:27], v[84:99]
    v_cvt_pk_bf16_f32 v142, v104, v105
    v_cvt_pk_bf16_f32 v143, v106, v107
    v_exp_f32 v108, v108
    v_exp_f32 v109, v109
    v_mfma_f32_32x32x16_bf16 v[164:179], v[52:55], v[140:143], v[164:179]
    v_exp_f32 v110, v110
    v_exp_f32 v111, v111
    v_cvt_pk_bf16_f32 v144, v108, v109
    v_cvt_pk_bf16_f32 v145, v110, v111
    v_mfma_f32_32x32x16_bf16 v[116:131], v[44:47], v[28:31], 0
    v_exp_f32 v112, v112
    v_exp_f32 v113, v113
    v_exp_f32 v114, v114
    v_exp_f32 v115, v115
    v_mfma_f32_32x32x16_bf16 v[116:131], v[48:51], v[32:35], v[116:131]
    v_cvt_pk_bf16_f32 v146, v112, v113
    v_cvt_pk_bf16_f32 v147, v114, v115
    s_waitcnt vmcnt(2) lgkmcnt(0)
    s_barrier
    ds_read_b128 v[36:39], v2 offset:0
    ds_read_b128 v[40:43], v2 offset:1024
    v_exp_f32 v84, v84
    v_exp_f32 v85, v85
    v_mfma_f32_32x32x16_bf16 v[164:179], v[56:59], v[144:147], v[164:179]
    ds_read_b128 v[52:55], v2 offset:2048
    ds_read_b128 v[56:59], v2 offset:3072
    v_exp_f32 v86, v86
    s_add_u32 m0, s41, 32768
    s_add_u32 s45, s40, 131072
    buffer_load_dwordx4 v1, s[20:23], s45 offen sc1 lds
    v_exp_f32 v87, v87
    v_cvt_pk_bf16_f32 v132, v84, v85
    v_cvt_pk_bf16_f32 v133, v86, v87
    v_exp_f32 v88, v88
    v_exp_f32 v89, v89
    v_exp_f32 v90, v90
    v_exp_f32 v91, v91
    buffer_load_dwordx4 v1, s[20:23], s45 offen offset:1024 sc1 lds
    v_cvt_pk_bf16_f32 v134, v88, v89
    v_cvt_pk_bf16_f32 v135, v90, v91
    v_exp_f32 v92, v92
    v_exp_f32 v93, v93
    v_mfma_f32_32x32x16_bf16 v[148:163], v[60:63], v[132:135], v[148:163]
    v_exp_f32 v94, v94
    v_exp_f32 v95, v95
    v_cvt_pk_bf16_f32 v136, v92, v93
    v_cvt_pk_bf16_f32 v137, v94, v95
    s_waitcnt lgkmcnt(3)
    v_mfma_f32_32x32x16_bf16 v[68:83], v[36:39], v[20:23], 0
    v_exp_f32 v96, v96
    v_exp_f32 v97, v97
    v_exp_f32 v98, v98
    v_exp_f32 v99, v99
    v_cvt_pk_bf16_f32 v138, v96, v97
    v_cvt_pk_bf16_f32 v139, v98, v99
    v_exp_f32 v116, v116
    v_exp_f32 v117, v117
    v_mfma_f32_32x32x16_bf16 v[148:163], v[64:67], v[136:139], v[148:163]
    v_exp_f32 v118, v118
    v_exp_f32 v119, v119
    v_cvt_pk_bf16_f32 v140, v116, v117
    v_cvt_pk_bf16_f32 v141, v118, v119
    v_exp_f32 v120, v120
    v_exp_f32 v121, v121
    v_exp_f32 v122, v122
    v_exp_f32 v123, v123
    s_waitcnt lgkmcnt(2)
    v_mfma_f32_32x32x16_bf16 v[68:83], v[40:43], v[24:27], v[68:83]
    v_cvt_pk_bf16_f32 v142, v120, v121
    v_cvt_pk_bf16_f32 v143, v122, v123
    v_exp_f32 v124, v124
    v_exp_f32 v125, v125
    v_mfma_f32_32x32x16_bf16 v[164:179], v[60:63], v[140:143], v[164:179]
    v_exp_f32 v126, v126
    v_exp_f32 v127, v127
    v_cvt_pk_bf16_f32 v144, v124, v125
    v_cvt_pk_bf16_f32 v145, v126, v127
    v_mfma_f32_32x32x16_bf16 v[100:115], v[36:39], v[28:31], 0
    v_exp_f32 v128, v128
    v_exp_f32 v129, v129
    v_exp_f32 v130, v130
    v_exp_f32 v131, v131
    v_mfma_f32_32x32x16_bf16 v[100:115], v[40:43], v[32:35], v[100:115]
    v_cvt_pk_bf16_f32 v146, v128, v129
    v_cvt_pk_bf16_f32 v147, v130, v131
    s_waitcnt vmcnt(2) lgkmcnt(0)
    s_barrier
    ds_read_b128 v[44:47], v2 offset:16384
    ds_read_b128 v[48:51], v2 offset:17408
    v_exp_f32 v68, v68
    v_exp_f32 v69, v69
    v_mfma_f32_32x32x16_bf16 v[164:179], v[64:67], v[144:147], v[164:179]
    ds_read_b128 v[60:63], v2 offset:18432
    ds_read_b128 v[64:67], v2 offset:19456
    v_exp_f32 v70, v70
    s_add_u32 m0, s41, 0
    s_add_u32 s45, s40, 147456
    buffer_load_dwordx4 v1, s[20:23], s45 offen sc1 lds
    v_exp_f32 v71, v71
    v_cvt_pk_bf16_f32 v132, v68, v69
    v_cvt_pk_bf16_f32 v133, v70, v71
    v_exp_f32 v72, v72
    v_exp_f32 v73, v73
    v_exp_f32 v74, v74
    v_exp_f32 v75, v75
    buffer_load_dwordx4 v1, s[20:23], s45 offen offset:1024 sc1 lds
    v_cvt_pk_bf16_f32 v134, v72, v73
    v_cvt_pk_bf16_f32 v135, v74, v75
    v_exp_f32 v76, v76
    v_exp_f32 v77, v77
    v_mfma_f32_32x32x16_bf16 v[148:163], v[52:55], v[132:135], v[148:163]
    v_exp_f32 v78, v78
    v_exp_f32 v79, v79
    v_cvt_pk_bf16_f32 v136, v76, v77
    v_cvt_pk_bf16_f32 v137, v78, v79
    s_waitcnt lgkmcnt(3)
    v_mfma_f32_32x32x16_bf16 v[84:99], v[44:47], v[20:23], 0
    v_exp_f32 v80, v80
    v_exp_f32 v81, v81
    v_exp_f32 v82, v82
    v_exp_f32 v83, v83
    v_cvt_pk_bf16_f32 v138, v80, v81
    v_cvt_pk_bf16_f32 v139, v82, v83
    v_exp_f32 v100, v100
    v_exp_f32 v101, v101
    v_mfma_f32_32x32x16_bf16 v[148:163], v[56:59], v[136:139], v[148:163]
    v_exp_f32 v102, v102
    v_exp_f32 v103, v103
    v_cvt_pk_bf16_f32 v140, v100, v101
    v_cvt_pk_bf16_f32 v141, v102, v103
    v_exp_f32 v104, v104
    v_exp_f32 v105, v105
    v_exp_f32 v106, v106
    v_exp_f32 v107, v107
    s_waitcnt lgkmcnt(2)
    v_mfma_f32_32x32x16_bf16 v[84:99], v[48:51], v[24:27], v[84:99]
    v_cvt_pk_bf16_f32 v142, v104, v105
    v_cvt_pk_bf16_f32 v143, v106, v107
    v_exp_f32 v108, v108
    v_exp_f32 v109, v109
    v_mfma_f32_32x32x16_bf16 v[164:179], v[52:55], v[140:143], v[164:179]
    v_exp_f32 v110, v110
    v_exp_f32 v111, v111
    v_cvt_pk_bf16_f32 v144, v108, v109
    v_cvt_pk_bf16_f32 v145, v110, v111
    v_mfma_f32_32x32x16_bf16 v[116:131], v[44:47], v[28:31], 0
    v_exp_f32 v112, v112
    v_exp_f32 v113, v113
    v_exp_f32 v114, v114
    v_exp_f32 v115, v115
    v_mfma_f32_32x32x16_bf16 v[116:131], v[48:51], v[32:35], v[116:131]
    v_cvt_pk_bf16_f32 v146, v112, v113
    v_cvt_pk_bf16_f32 v147, v114, v115
    s_waitcnt vmcnt(2) lgkmcnt(0)
    s_barrier
    ds_read_b128 v[36:39], v2 offset:32768
    ds_read_b128 v[40:43], v2 offset:33792
    v_exp_f32 v84, v84
    v_exp_f32 v85, v85
    v_mfma_f32_32x32x16_bf16 v[164:179], v[56:59], v[144:147], v[164:179]
    ds_read_b128 v[52:55], v2 offset:34816
    ds_read_b128 v[56:59], v2 offset:35840
    v_exp_f32 v86, v86
    s_add_u32 m0, s41, 16384
    s_add_u32 s45, s40, 163840
    buffer_load_dwordx4 v1, s[20:23], s45 offen sc1 lds
    v_exp_f32 v87, v87
    v_cvt_pk_bf16_f32 v132, v84, v85
    v_cvt_pk_bf16_f32 v133, v86, v87
    v_exp_f32 v88, v88
    v_exp_f32 v89, v89
    v_exp_f32 v90, v90
    v_exp_f32 v91, v91
    buffer_load_dwordx4 v1, s[20:23], s45 offen offset:1024 sc1 lds
    v_cvt_pk_bf16_f32 v134, v88, v89
    v_cvt_pk_bf16_f32 v135, v90, v91
    v_exp_f32 v92, v92
    v_exp_f32 v93, v93
    v_mfma_f32_32x32x16_bf16 v[148:163], v[60:63], v[132:135], v[148:163]
    v_exp_f32 v94, v94
    v_exp_f32 v95, v95
    v_cvt_pk_bf16_f32 v136, v92, v93
    v_cvt_pk_bf16_f32 v137, v94, v95
    s_waitcnt lgkmcnt(3)
    v_mfma_f32_32x32x16_bf16 v[68:83], v[36:39], v[20:23], 0
    v_exp_f32 v96, v96
    v_exp_f32 v97, v97
    v_exp_f32 v98, v98
    v_exp_f32 v99, v99
    v_cvt_pk_bf16_f32 v138, v96, v97
    v_cvt_pk_bf16_f32 v139, v98, v99
    v_exp_f32 v116, v116
    v_exp_f32 v117, v117
    v_mfma_f32_32x32x16_bf16 v[148:163], v[64:67], v[136:139], v[148:163]
    v_exp_f32 v118, v118
    v_exp_f32 v119, v119
    v_cvt_pk_bf16_f32 v140, v116, v117
    v_cvt_pk_bf16_f32 v141, v118, v119
    v_exp_f32 v120, v120
    v_exp_f32 v121, v121
    v_exp_f32 v122, v122
    v_exp_f32 v123, v123
    s_waitcnt lgkmcnt(2)
    v_mfma_f32_32x32x16_bf16 v[68:83], v[40:43], v[24:27], v[68:83]
    v_cvt_pk_bf16_f32 v142, v120, v121
    v_cvt_pk_bf16_f32 v143, v122, v123
    v_exp_f32 v124, v124
    v_exp_f32 v125, v125
    v_mfma_f32_32x32x16_bf16 v[164:179], v[60:63], v[140:143], v[164:179]
    v_exp_f32 v126, v126
    v_exp_f32 v127, v127
    v_cvt_pk_bf16_f32 v144, v124, v125
    v_cvt_pk_bf16_f32 v145, v126, v127
    v_mfma_f32_32x32x16_bf16 v[100:115], v[36:39], v[28:31], 0
    v_exp_f32 v128, v128
    v_exp_f32 v129, v129
    v_exp_f32 v130, v130
    v_exp_f32 v131, v131
    v_mfma_f32_32x32x16_bf16 v[100:115], v[40:43], v[32:35], v[100:115]
    v_cvt_pk_bf16_f32 v146, v128, v129
    v_cvt_pk_bf16_f32 v147, v130, v131
    s_waitcnt vmcnt(2) lgkmcnt(0)
    s_barrier
    ds_read_b128 v[44:47], v2 offset:0
    ds_read_b128 v[48:51], v2 offset:1024
    v_exp_f32 v68, v68
    v_exp_f32 v69, v69
    v_mfma_f32_32x32x16_bf16 v[164:179], v[64:67], v[144:147], v[164:179]
    ds_read_b128 v[60:63], v2 offset:2048
    ds_read_b128 v[64:67], v2 offset:3072
    v_exp_f32 v70, v70
    s_add_u32 m0, s41, 32768
    s_add_u32 s45, s40, 180224
    buffer_load_dwordx4 v1, s[20:23], s45 offen sc1 lds
    v_exp_f32 v71, v71
    v_cvt_pk_bf16_f32 v132, v68, v69
    v_cvt_pk_bf16_f32 v133, v70, v71
    v_exp_f32 v72, v72
    v_exp_f32 v73, v73
    v_exp_f32 v74, v74
    v_exp_f32 v75, v75
    buffer_load_dwordx4 v1, s[20:23], s45 offen offset:1024 sc1 lds
    v_cvt_pk_bf16_f32 v134, v72, v73
    v_cvt_pk_bf16_f32 v135, v74, v75
    v_exp_f32 v76, v76
    v_exp_f32 v77, v77
    v_mfma_f32_32x32x16_bf16 v[148:163], v[52:55], v[132:135], v[148:163]
    v_exp_f32 v78, v78
    v_exp_f32 v79, v79
    v_cvt_pk_bf16_f32 v136, v76, v77
    v_cvt_pk_bf16_f32 v137, v78, v79
    s_waitcnt lgkmcnt(3)
    v_mfma_f32_32x32x16_bf16 v[84:99], v[44:47], v[20:23], 0
    v_exp_f32 v80, v80
    v_exp_f32 v81, v81
    v_exp_f32 v82, v82
    v_exp_f32 v83, v83
    v_cvt_pk_bf16_f32 v138, v80, v81
    v_cvt_pk_bf16_f32 v139, v82, v83
    v_exp_f32 v100, v100
    v_exp_f32 v101, v101
    v_mfma_f32_32x32x16_bf16 v[148:163], v[56:59], v[136:139], v[148:163]
    v_exp_f32 v102, v102
    v_exp_f32 v103, v103
    v_cvt_pk_bf16_f32 v140, v100, v101
    v_cvt_pk_bf16_f32 v141, v102, v103
    v_exp_f32 v104, v104
    v_exp_f32 v105, v105
    v_exp_f32 v106, v106
    v_exp_f32 v107, v107
    s_waitcnt lgkmcnt(2)
    v_mfma_f32_32x32x16_bf16 v[84:99], v[48:51], v[24:27], v[84:99]
    v_cvt_pk_bf16_f32 v142, v104, v105
    v_cvt_pk_bf16_f32 v143, v106, v107
    v_exp_f32 v108, v108
    v_exp_f32 v109, v109
    v_mfma_f32_32x32x16_bf16 v[164:179], v[52:55], v[140:143], v[164:179]
    v_exp_f32 v110, v110
    v_exp_f32 v111, v111
    v_cvt_pk_bf16_f32 v144, v108, v109
    v_cvt_pk_bf16_f32 v145, v110, v111
    v_mfma_f32_32x32x16_bf16 v[116:131], v[44:47], v[28:31], 0
    v_exp_f32 v112, v112
    v_exp_f32 v113, v113
    v_exp_f32 v114, v114
    v_exp_f32 v115, v115
    v_mfma_f32_32x32x16_bf16 v[116:131], v[48:51], v[32:35], v[116:131]
    v_cvt_pk_bf16_f32 v146, v112, v113
    v_cvt_pk_bf16_f32 v147, v114, v115
    s_waitcnt vmcnt(2) lgkmcnt(0)
    s_barrier
    ds_read_b128 v[36:39], v2 offset:16384
    ds_read_b128 v[40:43], v2 offset:17408
    v_exp_f32 v84, v84
    v_exp_f32 v85, v85
    v_mfma_f32_32x32x16_bf16 v[164:179], v[56:59], v[144:147], v[164:179]
    ds_read_b128 v[52:55], v2 offset:18432
    ds_read_b128 v[56:59], v2 offset:19456
    v_exp_f32 v86, v86
    s_add_u32 m0, s41, 0
    s_add_u32 s45, s40, 196608
    buffer_load_dwordx4 v1, s[20:23], s45 offen sc1 lds
    v_exp_f32 v87, v87
    v_cvt_pk_bf16_f32 v132, v84, v85
    v_cvt_pk_bf16_f32 v133, v86, v87
    v_exp_f32 v88, v88
    v_exp_f32 v89, v89
    v_exp_f32 v90, v90
    v_exp_f32 v91, v91
    buffer_load_dwordx4 v1, s[20:23], s45 offen offset:1024 sc1 lds
    v_cvt_pk_bf16_f32 v134, v88, v89
    v_cvt_pk_bf16_f32 v135, v90, v91
    v_exp_f32 v92, v92
    v_exp_f32 v93, v93
    v_mfma_f32_32x32x16_bf16 v[148:163], v[60:63], v[132:135], v[148:163]
    v_exp_f32 v94, v94
    v_exp_f32 v95, v95
    v_cvt_pk_bf16_f32 v136, v92, v93
    v_cvt_pk_bf16_f32 v137, v94, v95
    s_waitcnt lgkmcnt(3)
    v_mfma_f32_32x32x16_bf16 v[68:83], v[36:39], v[20:23], 0
    v_exp_f32 v96, v96
    v_exp_f32 v97, v97
    v_exp_f32 v98, v98
    v_exp_f32 v99, v99
    v_cvt_pk_bf16_f32 v138, v96, v97
    v_cvt_pk_bf16_f32 v139, v98, v99
    v_exp_f32 v116, v116
    v_exp_f32 v117, v117
    v_mfma_f32_32x32x16_bf16 v[148:163], v[64:67], v[136:139], v[148:163]
    v_exp_f32 v118, v118
    v_exp_f32 v119, v119
    v_cvt_pk_bf16_f32 v140, v116, v117
    v_cvt_pk_bf16_f32 v141, v118, v119
    v_exp_f32 v120, v120
    v_exp_f32 v121, v121
    v_exp_f32 v122, v122
    v_exp_f32 v123, v123
    s_waitcnt lgkmcnt(2)
    v_mfma_f32_32x32x16_bf16 v[68:83], v[40:43], v[24:27], v[68:83]
    v_cvt_pk_bf16_f32 v142, v120, v121
    v_cvt_pk_bf16_f32 v143, v122, v123
    v_exp_f32 v124, v124
    v_exp_f32 v125, v125
    v_mfma_f32_32x32x16_bf16 v[164:179], v[60:63], v[140:143], v[164:179]
    v_exp_f32 v126, v126
    v_exp_f32 v127, v127
    v_cvt_pk_bf16_f32 v144, v124, v125
    v_cvt_pk_bf16_f32 v145, v126, v127
    v_mfma_f32_32x32x16_bf16 v[100:115], v[36:39], v[28:31], 0
    v_exp_f32 v128, v128
    v_exp_f32 v129, v129
    v_exp_f32 v130, v130
    v_exp_f32 v131, v131
    v_mfma_f32_32x32x16_bf16 v[100:115], v[40:43], v[32:35], v[100:115]
    v_cvt_pk_bf16_f32 v146, v128, v129
    v_cvt_pk_bf16_f32 v147, v130, v131
    s_waitcnt vmcnt(2) lgkmcnt(0)
    s_barrier
    ds_read_b128 v[44:47], v2 offset:32768
    ds_read_b128 v[48:51], v2 offset:33792
    v_exp_f32 v68, v68
    v_exp_f32 v69, v69
    v_mfma_f32_32x32x16_bf16 v[164:179], v[64:67], v[144:147], v[164:179]
    ds_read_b128 v[60:63], v2 offset:34816
    ds_read_b128 v[64:67], v2 offset:35840
    v_exp_f32 v70, v70
    s_add_u32 m0, s41, 16384
    s_add_u32 s45, s40, 212992
    buffer_load_dwordx4 v1, s[20:23], s45 offen sc1 lds
    v_exp_f32 v71, v71
    v_cvt_pk_bf16_f32 v132, v68, v69
    v_cvt_pk_bf16_f32 v133, v70, v71
    v_exp_f32 v72, v72
    v_exp_f32 v73, v73
    v_exp_f32 v74, v74
    v_exp_f32 v75, v75
    buffer_load_dwordx4 v1, s[20:23], s45 offen offset:1024 sc1 lds
    v_cvt_pk_bf16_f32 v134, v72, v73
    v_cvt_pk_bf16_f32 v135, v74, v75
    v_exp_f32 v76, v76
    v_exp_f32 v77, v77
    v_mfma_f32_32x32x16_bf16 v[148:163], v[52:55], v[132:135], v[148:163]
    v_exp_f32 v78, v78
    v_exp_f32 v79, v79
    v_cvt_pk_bf16_f32 v136, v76, v77
    v_cvt_pk_bf16_f32 v137, v78, v79
    s_waitcnt lgkmcnt(3)
    v_mfma_f32_32x32x16_bf16 v[84:99], v[44:47], v[20:23], 0
    v_exp_f32 v80, v80
    v_exp_f32 v81, v81
    v_exp_f32 v82, v82
    v_exp_f32 v83, v83
    v_cvt_pk_bf16_f32 v138, v80, v81
    v_cvt_pk_bf16_f32 v139, v82, v83
    v_exp_f32 v100, v100
    v_exp_f32 v101, v101
    v_mfma_f32_32x32x16_bf16 v[148:163], v[56:59], v[136:139], v[148:163]
    v_exp_f32 v102, v102
    v_exp_f32 v103, v103
    v_cvt_pk_bf16_f32 v140, v100, v101
    v_cvt_pk_bf16_f32 v141, v102, v103
    v_exp_f32 v104, v104
    v_exp_f32 v105, v105
    v_exp_f32 v106, v106
    v_exp_f32 v107, v107
    s_waitcnt lgkmcnt(2)
    v_mfma_f32_32x32x16_bf16 v[84:99], v[48:51], v[24:27], v[84:99]
    v_cvt_pk_bf16_f32 v142, v104, v105
    v_cvt_pk_bf16_f32 v143, v106, v107
    v_exp_f32 v108, v108
    v_exp_f32 v109, v109
    v_mfma_f32_32x32x16_bf16 v[164:179], v[52:55], v[140:143], v[164:179]
    v_exp_f32 v110, v110
    v_exp_f32 v111, v111
    v_cvt_pk_bf16_f32 v144, v108, v109
    v_cvt_pk_bf16_f32 v145, v110, v111
    v_mfma_f32_32x32x16_bf16 v[116:131], v[44:47], v[28:31], 0
    v_exp_f32 v112, v112
    v_exp_f32 v113, v113
    v_exp_f32 v114, v114
    v_exp_f32 v115, v115
    v_mfma_f32_32x32x16_bf16 v[116:131], v[48:51], v[32:35], v[116:131]
    v_cvt_pk_bf16_f32 v146, v112, v113
    v_cvt_pk_bf16_f32 v147, v114, v115
    s_waitcnt vmcnt(2) lgkmcnt(0)
    s_barrier
    ds_read_b128 v[36:39], v2 offset:0
    ds_read_b128 v[40:43], v2 offset:1024
    v_exp_f32 v84, v84
    v_exp_f32 v85, v85
    v_mfma_f32_32x32x16_bf16 v[164:179], v[56:59], v[144:147], v[164:179]
    ds_read_b128 v[52:55], v2 offset:2048
    ds_read_b128 v[56:59], v2 offset:3072
    v_exp_f32 v86, v86
    s_add_u32 m0, s41, 32768
    s_add_u32 s45, s40, 229376
    buffer_load_dwordx4 v1, s[20:23], s45 offen sc1 lds
    v_exp_f32 v87, v87
    v_cvt_pk_bf16_f32 v132, v84, v85
    v_cvt_pk_bf16_f32 v133, v86, v87
    v_exp_f32 v88, v88
    v_exp_f32 v89, v89
    v_exp_f32 v90, v90
    v_exp_f32 v91, v91
    buffer_load_dwordx4 v1, s[20:23], s45 offen offset:1024 sc1 lds
    v_cvt_pk_bf16_f32 v134, v88, v89
    v_cvt_pk_bf16_f32 v135, v90, v91
    v_exp_f32 v92, v92
    v_exp_f32 v93, v93
    v_mfma_f32_32x32x16_bf16 v[148:163], v[60:63], v[132:135], v[148:163]
    v_exp_f32 v94, v94
    v_exp_f32 v95, v95
    v_cvt_pk_bf16_f32 v136, v92, v93
    v_cvt_pk_bf16_f32 v137, v94, v95
    s_waitcnt lgkmcnt(3)
    v_mfma_f32_32x32x16_bf16 v[68:83], v[36:39], v[20:23], 0
    v_exp_f32 v96, v96
    v_exp_f32 v97, v97
    v_exp_f32 v98, v98
    v_exp_f32 v99, v99
    v_cvt_pk_bf16_f32 v138, v96, v97
    v_cvt_pk_bf16_f32 v139, v98, v99
    v_exp_f32 v116, v116
    v_exp_f32 v117, v117
    v_mfma_f32_32x32x16_bf16 v[148:163], v[64:67], v[136:139], v[148:163]
    v_exp_f32 v118, v118
    v_exp_f32 v119, v119
    v_cvt_pk_bf16_f32 v140, v116, v117
    v_cvt_pk_bf16_f32 v141, v118, v119
    v_exp_f32 v120, v120
    v_exp_f32 v121, v121
    v_exp_f32 v122, v122
    v_exp_f32 v123, v123
    s_waitcnt lgkmcnt(2)
    v_mfma_f32_32x32x16_bf16 v[68:83], v[40:43], v[24:27], v[68:83]
    v_cvt_pk_bf16_f32 v142, v120, v121
    v_cvt_pk_bf16_f32 v143, v122, v123
    v_exp_f32 v124, v124
    v_exp_f32 v125, v125
    v_mfma_f32_32x32x16_bf16 v[164:179], v[60:63], v[140:143], v[164:179]
    v_exp_f32 v126, v126
    v_exp_f32 v127, v127
    v_cvt_pk_bf16_f32 v144, v124, v125
    v_cvt_pk_bf16_f32 v145, v126, v127
    v_mfma_f32_32x32x16_bf16 v[100:115], v[36:39], v[28:31], 0
    v_exp_f32 v128, v128
    v_exp_f32 v129, v129
    v_exp_f32 v130, v130
    v_exp_f32 v131, v131
    v_mfma_f32_32x32x16_bf16 v[100:115], v[40:43], v[32:35], v[100:115]
    v_cvt_pk_bf16_f32 v146, v128, v129
    v_cvt_pk_bf16_f32 v147, v130, v131
    s_waitcnt vmcnt(2) lgkmcnt(0)
    s_barrier
    ds_read_b128 v[44:47], v2 offset:16384
    ds_read_b128 v[48:51], v2 offset:17408
    v_exp_f32 v68, v68
    v_exp_f32 v69, v69
    v_mfma_f32_32x32x16_bf16 v[164:179], v[64:67], v[144:147], v[164:179]
    ds_read_b128 v[60:63], v2 offset:18432
    ds_read_b128 v[64:67], v2 offset:19456
    v_exp_f32 v70, v70
    s_add_u32 m0, s41, 0
    s_add_u32 s45, s40, 245760
    buffer_load_dwordx4 v1, s[20:23], s45 offen sc1 lds
    v_exp_f32 v71, v71
    v_cvt_pk_bf16_f32 v132, v68, v69
    v_cvt_pk_bf16_f32 v133, v70, v71
    v_exp_f32 v72, v72
    v_exp_f32 v73, v73
    v_exp_f32 v74, v74
    v_exp_f32 v75, v75
    buffer_load_dwordx4 v1, s[20:23], s45 offen offset:1024 sc1 lds
    v_cvt_pk_bf16_f32 v134, v72, v73
    v_cvt_pk_bf16_f32 v135, v74, v75
    v_exp_f32 v76, v76
    v_exp_f32 v77, v77
    v_mfma_f32_32x32x16_bf16 v[148:163], v[52:55], v[132:135], v[148:163]
    v_exp_f32 v78, v78
    v_exp_f32 v79, v79
    v_cvt_pk_bf16_f32 v136, v76, v77
    v_cvt_pk_bf16_f32 v137, v78, v79
    s_waitcnt lgkmcnt(3)
    v_mfma_f32_32x32x16_bf16 v[84:99], v[44:47], v[20:23], 0
    v_exp_f32 v80, v80
    v_exp_f32 v81, v81
    v_exp_f32 v82, v82
    v_exp_f32 v83, v83
    v_cvt_pk_bf16_f32 v138, v80, v81
    v_cvt_pk_bf16_f32 v139, v82, v83
    v_exp_f32 v100, v100
    v_exp_f32 v101, v101
    v_mfma_f32_32x32x16_bf16 v[148:163], v[56:59], v[136:139], v[148:163]
    v_exp_f32 v102, v102
    v_exp_f32 v103, v103
    v_cvt_pk_bf16_f32 v140, v100, v101
    v_cvt_pk_bf16_f32 v141, v102, v103
    v_exp_f32 v104, v104
    v_exp_f32 v105, v105
    v_exp_f32 v106, v106
    v_exp_f32 v107, v107
    s_waitcnt lgkmcnt(2)
    v_mfma_f32_32x32x16_bf16 v[84:99], v[48:51], v[24:27], v[84:99]
    v_cvt_pk_bf16_f32 v142, v104, v105
    v_cvt_pk_bf16_f32 v143, v106, v107
    v_exp_f32 v108, v108
    v_exp_f32 v109, v109
    v_mfma_f32_32x32x16_bf16 v[164:179], v[52:55], v[140:143], v[164:179]
    v_exp_f32 v110, v110
    v_exp_f32 v111, v111
    v_cvt_pk_bf16_f32 v144, v108, v109
    v_cvt_pk_bf16_f32 v145, v110, v111
    v_mfma_f32_32x32x16_bf16 v[116:131], v[44:47], v[28:31], 0
    v_exp_f32 v112, v112
    v_exp_f32 v113, v113
    v_exp_f32 v114, v114
    v_exp_f32 v115, v115
    v_mfma_f32_32x32x16_bf16 v[116:131], v[48:51], v[32:35], v[116:131]
    v_cvt_pk_bf16_f32 v146, v112, v113
    v_cvt_pk_bf16_f32 v147, v114, v115
    s_waitcnt vmcnt(2) lgkmcnt(0)
    s_barrier
    ds_read_b128 v[36:39], v2 offset:32768
    ds_read_b128 v[40:43], v2 offset:33792
    v_exp_f32 v84, v84
    v_exp_f32 v85, v85
    v_mfma_f32_32x32x16_bf16 v[164:179], v[56:59], v[144:147], v[164:179]
    ds_read_b128 v[52:55], v2 offset:34816
    ds_read_b128 v[56:59], v2 offset:35840
    v_exp_f32 v86, v86
    v_exp_f32 v87, v87
    v_cvt_pk_bf16_f32 v132, v84, v85
    v_cvt_pk_bf16_f32 v133, v86, v87
    v_exp_f32 v88, v88
    v_exp_f32 v89, v89
    v_exp_f32 v90, v90
    v_exp_f32 v91, v91
    v_cvt_pk_bf16_f32 v134, v88, v89
    v_cvt_pk_bf16_f32 v135, v90, v91
    v_exp_f32 v92, v92
    v_exp_f32 v93, v93
    v_mfma_f32_32x32x16_bf16 v[148:163], v[60:63], v[132:135], v[148:163]
    v_exp_f32 v94, v94
    v_exp_f32 v95, v95
    v_cvt_pk_bf16_f32 v136, v92, v93
    v_cvt_pk_bf16_f32 v137, v94, v95
    s_waitcnt lgkmcnt(3)
    v_mfma_f32_32x32x16_bf16 v[68:83], v[36:39], v[20:23], 0
    v_exp_f32 v96, v96
    v_exp_f32 v97, v97
    v_exp_f32 v98, v98
    v_exp_f32 v99, v99
    v_cvt_pk_bf16_f32 v138, v96, v97
    v_cvt_pk_bf16_f32 v139, v98, v99
    v_exp_f32 v116, v116
    v_exp_f32 v117, v117
    v_mfma_f32_32x32x16_bf16 v[148:163], v[64:67], v[136:139], v[148:163]
    v_exp_f32 v118, v118
    v_exp_f32 v119, v119
    v_cvt_pk_bf16_f32 v140, v116, v117
    v_cvt_pk_bf16_f32 v141, v118, v119
    v_exp_f32 v120, v120
    v_exp_f32 v121, v121
    v_exp_f32 v122, v122
    v_exp_f32 v123, v123
    s_waitcnt lgkmcnt(2)
    v_mfma_f32_32x32x16_bf16 v[68:83], v[40:43], v[24:27], v[68:83]
    v_cvt_pk_bf16_f32 v142, v120, v121
    v_cvt_pk_bf16_f32 v143, v122, v123
    v_exp_f32 v124, v124
    v_exp_f32 v125, v125
    v_mfma_f32_32x32x16_bf16 v[164:179], v[60:63], v[140:143], v[164:179]
    v_exp_f32 v126, v126
    v_exp_f32 v127, v127
    v_cvt_pk_bf16_f32 v144, v124, v125
    v_cvt_pk_bf16_f32 v145, v126, v127
    v_mfma_f32_32x32x16_bf16 v[100:115], v[36:39], v[28:31], 0
    v_exp_f32 v128, v128
    v_exp_f32 v129, v129
    v_exp_f32 v130, v130
    v_exp_f32 v131, v131
    v_mfma_f32_32x32x16_bf16 v[100:115], v[40:43], v[32:35], v[100:115]
    v_cvt_pk_bf16_f32 v146, v128, v129
    v_cvt_pk_bf16_f32 v147, v130, v131
    s_waitcnt vmcnt(0) lgkmcnt(0)
    s_barrier
    ds_read_b128 v[44:47], v2 offset:0
    ds_read_b128 v[48:51], v2 offset:1024
    v_exp_f32 v68, v68
    v_exp_f32 v69, v69
    v_mfma_f32_32x32x16_bf16 v[164:179], v[64:67], v[144:147], v[164:179]
    ds_read_b128 v[60:63], v2 offset:2048
    ds_read_b128 v[64:67], v2 offset:3072
    v_exp_f32 v70, v70
    v_exp_f32 v71, v71
    v_cvt_pk_bf16_f32 v132, v68, v69
    v_cvt_pk_bf16_f32 v133, v70, v71
    v_exp_f32 v72, v72
    v_exp_f32 v73, v73
    v_exp_f32 v74, v74
    v_exp_f32 v75, v75
    v_cvt_pk_bf16_f32 v134, v72, v73
    v_cvt_pk_bf16_f32 v135, v74, v75
    v_exp_f32 v76, v76
    v_exp_f32 v77, v77
    v_mfma_f32_32x32x16_bf16 v[148:163], v[52:55], v[132:135], v[148:163]
    v_exp_f32 v78, v78
    v_exp_f32 v79, v79
    v_cvt_pk_bf16_f32 v136, v76, v77
    v_cvt_pk_bf16_f32 v137, v78, v79
    s_waitcnt lgkmcnt(3)
    v_mfma_f32_32x32x16_bf16 v[84:99], v[44:47], v[20:23], 0
    v_exp_f32 v80, v80
    v_exp_f32 v81, v81
    v_exp_f32 v82, v82
    v_exp_f32 v83, v83
    v_cvt_pk_bf16_f32 v138, v80, v81
    v_cvt_pk_bf16_f32 v139, v82, v83
    v_exp_f32 v100, v100
    v_exp_f32 v101, v101
    v_mfma_f32_32x32x16_bf16 v[148:163], v[56:59], v[136:139], v[148:163]
    v_exp_f32 v102, v102
    v_exp_f32 v103, v103
    v_cvt_pk_bf16_f32 v140, v100, v101
    v_cvt_pk_bf16_f32 v141, v102, v103
    v_exp_f32 v104, v104
    v_exp_f32 v105, v105
    v_exp_f32 v106, v106
    v_exp_f32 v107, v107
    s_waitcnt lgkmcnt(2)
    v_mfma_f32_32x32x16_bf16 v[84:99], v[48:51], v[24:27], v[84:99]
    v_cvt_pk_bf16_f32 v142, v104, v105
    v_cvt_pk_bf16_f32 v143, v106, v107
    v_exp_f32 v108, v108
    v_exp_f32 v109, v109
    v_mfma_f32_32x32x16_bf16 v[164:179], v[52:55], v[140:143], v[164:179]
    v_exp_f32 v110, v110
    v_exp_f32 v111, v111
    v_cvt_pk_bf16_f32 v144, v108, v109
    v_cvt_pk_bf16_f32 v145, v110, v111
    v_mfma_f32_32x32x16_bf16 v[116:131], v[44:47], v[28:31], 0
    v_exp_f32 v112, v112
    v_exp_f32 v113, v113
    v_exp_f32 v114, v114
    v_exp_f32 v115, v115
    v_mfma_f32_32x32x16_bf16 v[116:131], v[48:51], v[32:35], v[116:131]
    v_cvt_pk_bf16_f32 v146, v112, v113
    v_cvt_pk_bf16_f32 v147, v114, v115
    s_waitcnt lgkmcnt(0)
    s_barrier
    v_exp_f32 v84, v84
    v_exp_f32 v85, v85
    v_mfma_f32_32x32x16_bf16 v[164:179], v[56:59], v[144:147], v[164:179]
    v_exp_f32 v86, v86
    v_exp_f32 v87, v87
    v_cvt_pk_bf16_f32 v132, v84, v85
    v_cvt_pk_bf16_f32 v133, v86, v87
    v_exp_f32 v88, v88
    v_exp_f32 v89, v89
    v_exp_f32 v90, v90
    v_exp_f32 v91, v91
    v_cvt_pk_bf16_f32 v134, v88, v89
    v_cvt_pk_bf16_f32 v135, v90, v91
    v_exp_f32 v92, v92
    v_exp_f32 v93, v93
    v_mfma_f32_32x32x16_bf16 v[148:163], v[60:63], v[132:135], v[148:163]
    v_exp_f32 v94, v94
    v_exp_f32 v95, v95
    v_cvt_pk_bf16_f32 v136, v92, v93
    v_cvt_pk_bf16_f32 v137, v94, v95
    v_exp_f32 v96, v96
    v_exp_f32 v97, v97
    v_exp_f32 v98, v98
    v_exp_f32 v99, v99
    v_cvt_pk_bf16_f32 v138, v96, v97
    v_cvt_pk_bf16_f32 v139, v98, v99
    v_exp_f32 v116, v116
    v_exp_f32 v117, v117
    v_mfma_f32_32x32x16_bf16 v[148:163], v[64:67], v[136:139], v[148:163]
    v_exp_f32 v118, v118
    v_exp_f32 v119, v119
    v_cvt_pk_bf16_f32 v140, v116, v117
    v_cvt_pk_bf16_f32 v141, v118, v119
    v_exp_f32 v120, v120
    v_exp_f32 v121, v121
    v_exp_f32 v122, v122
    v_exp_f32 v123, v123
    v_cvt_pk_bf16_f32 v142, v120, v121
    v_cvt_pk_bf16_f32 v143, v122, v123
    v_exp_f32 v124, v124
    v_exp_f32 v125, v125
    v_mfma_f32_32x32x16_bf16 v[164:179], v[60:63], v[140:143], v[164:179]
    v_exp_f32 v126, v126
    v_exp_f32 v127, v127
    v_cvt_pk_bf16_f32 v144, v124, v125
    v_cvt_pk_bf16_f32 v145, v126, v127
    v_exp_f32 v128, v128
    v_exp_f32 v129, v129
    v_exp_f32 v130, v130
    v_exp_f32 v131, v131
    v_cvt_pk_bf16_f32 v146, v128, v129
    v_cvt_pk_bf16_f32 v147, v130, v131
    s_nop 1
    v_mfma_f32_32x32x16_bf16 v[164:179], v[64:67], v[144:147], v[164:179]
parallel_sum__softmax_full_mha__swiglu_ffn__prompt_kernel_b_tail:
    s_lshl_b32 s58, s36, 2
    s_add_u32 s58, s58, s37
    s_lshl_b32 s59, s58, 13
    s_cmp_ge_u32 s58, 6
    s_cselect_b32 s60, 98304, 0
    s_add_u32 s59, s59, s60
    v_add_u32 v240, s59, v1
    ds_write_b128 v240, v[148:151] offset:0
    ds_write_b128 v240, v[152:155] offset:1024
    ds_write_b128 v240, v[156:159] offset:2048
    ds_write_b128 v240, v[160:163] offset:3072
    s_nop 0
    ds_write_b128 v240, v[164:167] offset:4096
    ds_write_b128 v240, v[168:171] offset:5120
    ds_write_b128 v240, v[172:175] offset:6144
    ds_write_b128 v240, v[176:179] offset:7168
    s_lshr_b32 s59, s37, 1
    s_lshl_b32 s59, s59, 12
    s_and_b32 s60, s37, 1
    s_lshl_b32 s61, s60, 11
    s_add_u32 s61, s61, s59
    s_lshl_b32 s58, s36, 15
    v_or_b32 v243, 512, v1
    s_cmp_eq_u32 s36, 7
    s_add_u32 s45, s58, 0
    s_add_u32 s49, s45, s61
    v_add_u32 v244, s49, v1
    s_add_u32 s49, s45, s59
    v_add_u32 v248, s49, v243
    s_cmp_eq_u32 s36, 7
    s_add_u32 s45, s58, 8192
    s_add_u32 s49, s45, s61
    v_add_u32 v245, s49, v1
    s_add_u32 s49, s45, s59
    v_add_u32 v249, s49, v243
    s_cmp_eq_u32 s36, 1
    s_cselect_b32 s45, 98304, 0
    s_add_u32 s45, s45, s58
    s_add_u32 s45, s45, 16384
    s_add_u32 s49, s45, s61
    v_add_u32 v246, s49, v1
    s_add_u32 s49, s45, s59
    v_add_u32 v250, s49, v243
    s_cmp_eq_u32 s36, 1
    s_cselect_b32 s45, 98304, 0
    s_add_u32 s45, s45, s58
    s_add_u32 s45, s45, 24576
    s_add_u32 s49, s45, s61
    v_add_u32 v247, s49, v1
    s_add_u32 s49, s45, s59
    v_add_u32 v251, s49, v243
    s_waitcnt vmcnt(0) lgkmcnt(0)
    s_barrier
    ds_read_b128 v[68:71], v244
    ds_read_b128 v[72:75], v244 offset:1024
    ds_read_b32 v100, v248 offset:3072
    ds_read_b128 v[76:79], v245
    ds_read_b128 v[80:83], v245 offset:1024
    ds_read_b32 v101, v249 offset:3072
    ds_read_b128 v[84:87], v246
    ds_read_b128 v[88:91], v246 offset:1024
    ds_read_b32 v102, v250 offset:3072
    ds_read_b128 v[92:95], v247
    ds_read_b128 v[96:99], v247 offset:1024
    ds_read_b32 v103, v251 offset:3072
    s_waitcnt lgkmcnt(8)
    v_add_f32 v68, v68, v76
    s_waitcnt lgkmcnt(2)
    v_add_f32 v84, v84, v92
    v_add_f32 v69, v69, v77
    v_add_f32 v85, v85, v93
    v_add_f32 v70, v70, v78
    v_add_f32 v86, v86, v94
    v_add_f32 v71, v71, v79
    v_add_f32 v87, v87, v95
    v_add_f32 v72, v72, v80
    s_waitcnt lgkmcnt(1)
    v_add_f32 v88, v88, v96
    v_add_f32 v73, v73, v81
    v_add_f32 v89, v89, v97
    v_add_f32 v74, v74, v82
    v_add_f32 v90, v90, v98
    v_add_f32 v75, v75, v83
    v_add_f32 v91, v91, v99
    v_add_f32 v100, v100, v101
    s_waitcnt lgkmcnt(0)
    v_add_f32 v102, v102, v103
    v_add_f32 v68, v68, v84
    v_add_f32 v69, v69, v85
    v_add_f32 v70, v70, v86
    v_add_f32 v71, v71, v87
    v_add_f32 v72, v72, v88
    v_add_f32 v73, v73, v89
    v_add_f32 v74, v74, v90
    v_add_f32 v75, v75, v91
    v_add_f32 v244, v100, v102
    v_mul_f32 v245, 0, v68
    v_fma_f32 v245, v69, 0, v245
    v_fma_f32 v245, v70, 0, v245
    v_fma_f32 v245, v71, 0, v245
    v_fma_f32 v245, v72, 0, v245
    v_fma_f32 v245, v73, 0, v245
    v_fma_f32 v245, v74, 0, v245
    v_fma_f32 v245, v75, 0, v245
    v_add_f32 v245, v245, v244
    v_mov_b32 v246, 0x17800000
    v_mov_b32 v247, 0x7f800000
    v_cmp_ge_f32 s[58:59], v245, v246
    v_cmp_lt_f32 vcc, v245, v247
    s_nop 0
    s_and_b64 vcc, vcc, s[58:59]
    s_cmp_eq_u64 vcc, -1
    s_cbranch_scc0 parallel_sum__softmax_full_mha__swiglu_ffn__prompt_kernel_b_slow
parallel_sum__softmax_full_mha__swiglu_ffn__prompt_kernel_b_astore:
    v_rcp_f32 v245, v244
    s_nop 0
    v_mul_f32 v68, v68, v245
    v_mul_f32 v69, v69, v245
    v_mul_f32 v70, v70, v245
    v_mul_f32 v71, v71, v245
    v_mul_f32 v72, v72, v245
    v_mul_f32 v73, v73, v245
    v_mul_f32 v74, v74, v245
    v_mul_f32 v75, v75, v245
    v_cvt_pk_bf16_f32 v132, v68, v69
    v_cvt_pk_bf16_f32 v133, v70, v71
    v_cvt_pk_bf16_f32 v134, v72, v73
    v_cvt_pk_bf16_f32 v135, v74, v75
    s_and_b32 s60, s37, 1
    s_cmp_eq_u32 s60, 0
    s_cselect_b32 s59, 0, -1
    s_mov_b32 s58, 0
    v_mov_b32 v240, 0
    v_cndmask_b32 v134, v134, v240, s[58:59]
    v_cndmask_b32 v135, v135, v240, s[58:59]
    buffer_store_dwordx4 v[132:135], v1, s[20:23], s48 offen sc1
    s_cmp_eq_u32 s35, 0
    s_cbranch_scc1 parallel_sum__softmax_full_mha__swiglu_ffn__prompt_kernel_b_nog11
    ds_read_b64_tr_b16 v[228:229], v11 offset:0
    ds_read_b64_tr_b16 v[230:231], v11 offset:1024
    ds_read_b128 v[212:215], v8 offset:0
    ds_read_b128 v[216:219], v8 offset:8192
    ds_read_b64_tr_b16 v[232:233], v11 offset:2048
    ds_read_b64_tr_b16 v[234:235], v11 offset:3072
    ds_read_b128 v[220:223], v8 offset:1024
    ds_read_b128 v[224:227], v8 offset:9216
    s_waitcnt lgkmcnt(5)
    v_mfma_f32_32x32x16_bf16 v[180:195], v[228:231], v[212:215], v[180:195]
    s_waitcnt lgkmcnt(4)
    v_mfma_f32_32x32x16_bf16 v[196:211], v[228:231], v[216:219], v[196:211]
    s_waitcnt lgkmcnt(1)
    v_mfma_f32_32x32x16_bf16 v[180:195], v[232:235], v[220:223], v[180:195]
    s_waitcnt lgkmcnt(0)
    v_mfma_f32_32x32x16_bf16 v[196:211], v[232:235], v[224:227], v[196:211]
parallel_sum__softmax_full_mha__swiglu_ffn__prompt_kernel_b_nog11:
    s_waitcnt vmcnt(0)
    s_barrier
    s_cmp_eq_u32 s30, 0
    s_cbranch_scc0 parallel_sum__softmax_full_mha__swiglu_ffn__prompt_kernel_b_noflag
    s_lshl_b32 s60, s32, 4
    s_add_u32 s60, s60, s31
    s_lshl_b32 s60, s60, 2
    s_add_u32 s60, s60, 16784384
    v_mov_b32 v241, s3
    v_mov_b32 v240, 0
    buffer_store_dword v241, v240, s[20:23], s60 offen sc1
parallel_sum__softmax_full_mha__swiglu_ffn__prompt_kernel_b_noflag:
    s_cmp_eq_u32 s35, 0
    s_cbranch_scc1 parallel_sum__softmax_full_mha__swiglu_ffn__prompt_kernel_b_fin
    ds_read_b64_tr_b16 v[228:229], v9 offset:0
    ds_read_b64_tr_b16 v[230:231], v9 offset:1024
    ds_read_b128 v[212:215], v3 offset:0
    ds_read_b128 v[216:219], v3 offset:8192
    ds_read_b64_tr_b16 v[232:233], v9 offset:2048
    ds_read_b64_tr_b16 v[234:235], v9 offset:3072
    ds_read_b128 v[220:223], v3 offset:1024
    ds_read_b128 v[224:227], v3 offset:9216
    s_waitcnt lgkmcnt(5)
    v_mfma_f32_32x32x16_bf16 v[180:195], v[228:231], v[212:215], v[180:195]
    s_waitcnt lgkmcnt(4)
    v_mfma_f32_32x32x16_bf16 v[196:211], v[228:231], v[216:219], v[196:211]
    s_waitcnt lgkmcnt(1)
    v_mfma_f32_32x32x16_bf16 v[180:195], v[232:235], v[220:223], v[180:195]
    s_waitcnt lgkmcnt(0)
    v_mfma_f32_32x32x16_bf16 v[196:211], v[232:235], v[224:227], v[196:211]
    ds_read_b64_tr_b16 v[228:229], v10 offset:0
    ds_read_b64_tr_b16 v[230:231], v10 offset:1024
    ds_read_b128 v[212:215], v4 offset:0
    ds_read_b128 v[216:219], v4 offset:8192
    ds_read_b64_tr_b16 v[232:233], v10 offset:2048
    ds_read_b64_tr_b16 v[234:235], v10 offset:3072
    ds_read_b128 v[220:223], v4 offset:1024
    ds_read_b128 v[224:227], v4 offset:9216
    s_waitcnt lgkmcnt(5)
    v_mfma_f32_32x32x16_bf16 v[180:195], v[228:231], v[212:215], v[180:195]
    s_waitcnt lgkmcnt(4)
    v_mfma_f32_32x32x16_bf16 v[196:211], v[228:231], v[216:219], v[196:211]
    s_waitcnt lgkmcnt(1)
    v_mfma_f32_32x32x16_bf16 v[180:195], v[232:235], v[220:223], v[180:195]
    s_waitcnt lgkmcnt(0)
    v_mfma_f32_32x32x16_bf16 v[196:211], v[232:235], v[224:227], v[196:211]
    s_barrier
    s_add_u32 m0, s51, 105472
    s_add_u32 s59, s50, 0
    buffer_load_dwordx4 v16, s[12:15], s59 offen lds
    s_add_u32 m0, s51, 113664
    s_add_u32 s59, s50, 57344
    buffer_load_dwordx4 v16, s[12:15], s59 offen lds
    s_add_u32 m0, s51, 121856
    s_add_u32 s59, s50, 114688
    buffer_load_dwordx4 v16, s[12:15], s59 offen lds
    s_add_u32 m0, s51, 130048
    s_add_u32 s59, s50, 172032
    buffer_load_dwordx4 v16, s[12:15], s59 offen lds
    s_add_u32 m0, s51, 138240
    s_add_u32 s59, s50, 229376
    buffer_load_dwordx4 v16, s[12:15], s59 offen lds
    s_add_u32 m0, s51, 146432
    s_add_u32 s59, s50, 286720
    buffer_load_dwordx4 v16, s[12:15], s59 offen lds
    s_add_u32 m0, s51, 154624
    s_add_u32 s59, s50, 344064
    buffer_load_dwordx4 v16, s[12:15], s59 offen lds
    s_cmp_eq_u32 s30, 0
    s_cbranch_scc0 parallel_sum__softmax_full_mha__swiglu_ffn__prompt_kernel_b_nowo2
    s_add_u32 m0, s51, 162816
    s_add_u32 s59, s50, 401408
    buffer_load_dwordx4 v16, s[12:15], s59 offen lds
parallel_sum__softmax_full_mha__swiglu_ffn__prompt_kernel_b_nowo2:
    s_lshl_b32 s58, s30, 12
    s_add_u32 s58, s58, 65536
    v_add_u32 v240, s58, v1
    s_xor_b32 s58, s30, 4
    s_lshl_b32 s58, s58, 12
    s_add_u32 s58, s58, 65536
    v_add_u32 v241, s58, v1
    s_cmp_lt_u32 s30, 4
    s_cbranch_scc0 parallel_sum__softmax_full_mha__swiglu_ffn__prompt_kernel_b_sw1
    ds_write_b128 v240, v[196:199] offset:0
    ds_write_b128 v240, v[200:203] offset:1024
    ds_write_b128 v240, v[204:207] offset:2048
    ds_write_b128 v240, v[208:211] offset:3072
    s_branch parallel_sum__softmax_full_mha__swiglu_ffn__prompt_kernel_b_sw2
parallel_sum__softmax_full_mha__swiglu_ffn__prompt_kernel_b_sw1:
    ds_write_b128 v240, v[180:183] offset:0
    ds_write_b128 v240, v[184:187] offset:1024
    ds_write_b128 v240, v[188:191] offset:2048
    ds_write_b128 v240, v[192:195] offset:3072
    s_waitcnt lgkmcnt(0)
    v_mov_b32 v180, v196
    v_mov_b32 v181, v197
    v_mov_b32 v182, v198
    v_mov_b32 v183, v199
    v_mov_b32 v184, v200
    v_mov_b32 v185, v201
    v_mov_b32 v186, v202
    v_mov_b32 v187, v203
    v_mov_b32 v188, v204
    v_mov_b32 v189, v205
    v_mov_b32 v190, v206
    v_mov_b32 v191, v207
    v_mov_b32 v192, v208
    v_mov_b32 v193, v209
    v_mov_b32 v194, v210
    v_mov_b32 v195, v211
parallel_sum__softmax_full_mha__swiglu_ffn__prompt_kernel_b_sw2:
    s_waitcnt lgkmcnt(0)
    s_barrier
    ds_read_b128 v[68:71], v241 offset:0
    ds_read_b128 v[72:75], v241 offset:1024
    ds_read_b128 v[76:79], v241 offset:2048
    ds_read_b128 v[80:83], v241 offset:3072
    s_waitcnt lgkmcnt(3)
    v_add_f32 v180, v180, v68
    v_add_f32 v181, v181, v69
    v_add_f32 v182, v182, v70
    v_add_f32 v183, v183, v71
    s_waitcnt lgkmcnt(2)
    v_add_f32 v184, v184, v72
    v_add_f32 v185, v185, v73
    v_add_f32 v186, v186, v74
    v_add_f32 v187, v187, v75
    s_waitcnt lgkmcnt(1)
    v_add_f32 v188, v188, v76
    v_add_f32 v189, v189, v77
    v_add_f32 v190, v190, v78
    v_add_f32 v191, v191, v79
    s_waitcnt lgkmcnt(0)
    v_add_f32 v192, v192, v80
    v_add_f32 v193, v193, v81
    v_add_f32 v194, v194, v82
    v_add_f32 v195, v195, v83
    s_lshr_b32 s58, s33, 1
    s_lshl_b32 s58, s58, 6
    s_add_u32 s47, s58, 16784384
    v_and_b32 v240, 15, v0
    v_lshlrev_b32 v240, 2, v240
    s_mov_b32 s49, 0x100000
    buffer_load_dword v241, v240, s[20:23], s47 offen sc1
parallel_sum__softmax_full_mha__swiglu_ffn__prompt_kernel_b_poll:
    buffer_load_dword v242, v240, s[20:23], s47 offen sc1
    s_waitcnt vmcnt(1)
    v_cmp_eq_u32 vcc, s3, v241
    s_nop 0
    s_cmp_eq_u64 vcc, -1
    s_cbranch_scc1 parallel_sum__softmax_full_mha__swiglu_ffn__prompt_kernel_b_polled
    buffer_load_dword v241, v240, s[20:23], s47 offen sc1
    s_waitcnt vmcnt(1)
    v_cmp_eq_u32 vcc, s3, v242
    s_nop 0
    s_cmp_eq_u64 vcc, -1
    s_cbranch_scc1 parallel_sum__softmax_full_mha__swiglu_ffn__prompt_kernel_b_polled
    s_sub_u32 s49, s49, 1
    s_cmp_lg_u32 s49, 0
    s_cbranch_scc1 parallel_sum__softmax_full_mha__swiglu_ffn__prompt_kernel_b_poll
parallel_sum__softmax_full_mha__swiglu_ffn__prompt_kernel_b_polled:
    s_lshl_b32 s58, s33, 16
    s_lshl_b32 s59, s30, 13
    s_add_u32 s58, s58, s59
    s_add_u32 s58, s58, 14680064
    s_add_u32 m0, s59, 0
    s_nop 0
    buffer_load_dwordx4 v1, s[20:23], s58 offen offset:0 sc1 lds
    buffer_load_dwordx4 v1, s[20:23], s58 offen offset:1024 sc1 lds
    buffer_load_dwordx4 v1, s[20:23], s58 offen offset:2048 sc1 lds
    buffer_load_dwordx4 v1, s[20:23], s58 offen offset:3072 sc1 lds
    s_addk_i32 m0, 4096
    s_add_u32 s58, s58, 4096
    buffer_load_dwordx4 v1, s[20:23], s58 offen offset:0 sc1 lds
    buffer_load_dwordx4 v1, s[20:23], s58 offen offset:1024 sc1 lds
    buffer_load_dwordx4 v1, s[20:23], s58 offen offset:2048 sc1 lds
    buffer_load_dwordx4 v1, s[20:23], s58 offen offset:3072 sc1 lds
    s_and_b32 s60, s37, 1
    s_lshr_b32 s61, s37, 1
    s_lshl_b32 s58, s61, 15
    s_lshl_b32 s59, s60, 14
    s_add_u32 s58, s58, s59
    v_add_u32 v3, s58, v1
    s_mul_i32 s59, s60, 28672
    s_add_u32 s59, s59, 105472
    v_add_u32 v9, s59, v17
    s_lshl_b32 s58, s30, 11
    s_add_u32 s58, s58, 65536
    s_waitcnt vmcnt(8)
    v_add_u32 v242, s58, v1
    s_xor_b32 s58, s30, 2
    s_lshl_b32 s58, s58, 11
    s_add_u32 s58, s58, 65536
    v_add_u32 v243, s58, v1
    s_waitcnt vmcnt(0)
    s_barrier
    ds_read_b64_tr_b16 v[228:229], v9 offset:0
    ds_read_b64_tr_b16 v[230:231], v9 offset:1024
    ds_read_b128 v[212:215], v3 offset:0
    ds_read_b64_tr_b16 v[232:233], v9 offset:2048
    ds_read_b64_tr_b16 v[234:235], v9 offset:3072
    ds_read_b128 v[216:219], v3 offset:1024
    ds_read_b64_tr_b16 v[224:225], v9 offset:3584
    ds_read_b64_tr_b16 v[226:227], v9 offset:4608
    ds_read_b128 v[220:223], v3 offset:2048
    s_waitcnt lgkmcnt(6)
    v_mfma_f32_32x32x16_bf16 v[180:195], v[228:231], v[212:215], v[180:195]
    ds_read_b64_tr_b16 v[228:229], v9 offset:5632
    ds_read_b64_tr_b16 v[230:231], v9 offset:6656
    ds_read_b128 v[212:215], v3 offset:3072
    s_waitcnt lgkmcnt(6)
    v_mfma_f32_32x32x16_bf16 v[180:195], v[232:235], v[216:219], v[180:195]
    ds_read_b64_tr_b16 v[232:233], v9 offset:7168
    ds_read_b64_tr_b16 v[234:235], v9 offset:8192
    ds_read_b128 v[216:219], v3 offset:4096
    s_waitcnt lgkmcnt(6)
    v_mfma_f32_32x32x16_bf16 v[180:195], v[224:227], v[220:223], v[180:195]
    ds_read_b64_tr_b16 v[224:225], v9 offset:9216
    ds_read_b64_tr_b16 v[226:227], v9 offset:10240
    ds_read_b128 v[220:223], v3 offset:5120
    s_waitcnt lgkmcnt(6)
    v_mfma_f32_32x32x16_bf16 v[180:195], v[228:231], v[212:215], v[180:195]
    ds_read_b64_tr_b16 v[228:229], v9 offset:10752
    ds_read_b64_tr_b16 v[230:231], v9 offset:11776
    ds_read_b128 v[212:215], v3 offset:6144
    s_waitcnt lgkmcnt(6)
    v_mfma_f32_32x32x16_bf16 v[180:195], v[232:235], v[216:219], v[180:195]
    ds_read_b64_tr_b16 v[232:233], v9 offset:12800
    ds_read_b64_tr_b16 v[234:235], v9 offset:13824
    ds_read_b128 v[216:219], v3 offset:7168
    s_waitcnt lgkmcnt(6)
    v_mfma_f32_32x32x16_bf16 v[180:195], v[224:227], v[220:223], v[180:195]
    ds_read_b64_tr_b16 v[224:225], v9 offset:14336
    ds_read_b64_tr_b16 v[226:227], v9 offset:15360
    ds_read_b128 v[220:223], v3 offset:8192
    s_waitcnt lgkmcnt(6)
    v_mfma_f32_32x32x16_bf16 v[180:195], v[228:231], v[212:215], v[180:195]
    ds_read_b64_tr_b16 v[228:229], v9 offset:16384
    ds_read_b64_tr_b16 v[230:231], v9 offset:17408
    ds_read_b128 v[212:215], v3 offset:9216
    s_waitcnt lgkmcnt(6)
    v_mfma_f32_32x32x16_bf16 v[180:195], v[232:235], v[216:219], v[180:195]
    ds_read_b64_tr_b16 v[232:233], v9 offset:17920
    ds_read_b64_tr_b16 v[234:235], v9 offset:18944
    ds_read_b128 v[216:219], v3 offset:10240
    s_waitcnt lgkmcnt(6)
    v_mfma_f32_32x32x16_bf16 v[180:195], v[224:227], v[220:223], v[180:195]
    ds_read_b64_tr_b16 v[224:225], v9 offset:19968
    ds_read_b64_tr_b16 v[226:227], v9 offset:20992
    ds_read_b128 v[220:223], v3 offset:11264
    s_waitcnt lgkmcnt(6)
    v_mfma_f32_32x32x16_bf16 v[180:195], v[228:231], v[212:215], v[180:195]
    ds_read_b64_tr_b16 v[228:229], v9 offset:21504
    ds_read_b64_tr_b16 v[230:231], v9 offset:22528
    ds_read_b128 v[212:215], v3 offset:12288
    s_waitcnt lgkmcnt(6)
    v_mfma_f32_32x32x16_bf16 v[180:195], v[232:235], v[216:219], v[180:195]
    ds_read_b64_tr_b16 v[232:233], v9 offset:23552
    ds_read_b64_tr_b16 v[234:235], v9 offset:24576
    ds_read_b128 v[216:219], v3 offset:13312
    s_waitcnt lgkmcnt(6)
    v_mfma_f32_32x32x16_bf16 v[180:195], v[224:227], v[220:223], v[180:195]
    ds_read_b64_tr_b16 v[224:225], v9 offset:25088
    ds_read_b64_tr_b16 v[226:227], v9 offset:26112
    ds_read_b128 v[220:223], v3 offset:14336
    s_waitcnt lgkmcnt(6)
    v_mfma_f32_32x32x16_bf16 v[180:195], v[228:231], v[212:215], v[180:195]
    ds_read_b64_tr_b16 v[228:229], v9 offset:27136
    ds_read_b64_tr_b16 v[230:231], v9 offset:28160
    ds_read_b128 v[212:215], v3 offset:15360
    s_waitcnt lgkmcnt(6)
    v_mfma_f32_32x32x16_bf16 v[180:195], v[232:235], v[216:219], v[180:195]
    s_waitcnt lgkmcnt(3)
    v_mfma_f32_32x32x16_bf16 v[180:195], v[224:227], v[220:223], v[180:195]
    s_waitcnt lgkmcnt(0)
    v_mfma_f32_32x32x16_bf16 v[180:195], v[228:231], v[212:215], v[180:195]
    s_and_b32 s60, s37, 1
    s_cmp_eq_u32 s60, 0
    s_cbranch_scc0 parallel_sum__softmax_full_mha__swiglu_ffn__prompt_kernel_b_x1
    s_nop 8
    ds_write_b128 v242, v[188:191]
    ds_write_b128 v242, v[192:195] offset:1024
    s_branch parallel_sum__softmax_full_mha__swiglu_ffn__prompt_kernel_b_x2
parallel_sum__softmax_full_mha__swiglu_ffn__prompt_kernel_b_x1:
    s_nop 8
    ds_write_b128 v242, v[180:183]
    ds_write_b128 v242, v[184:187] offset:1024
    s_waitcnt lgkmcnt(0)
    v_mov_b32 v180, v188
    v_mov_b32 v181, v189
    v_mov_b32 v182, v190
    v_mov_b32 v183, v191
    v_mov_b32 v184, v192
    v_mov_b32 v185, v193
    v_mov_b32 v186, v194
    v_mov_b32 v187, v195
parallel_sum__softmax_full_mha__swiglu_ffn__prompt_kernel_b_x2:
    s_waitcnt lgkmcnt(0)
    s_barrier
    ds_read_b128 v[68:71], v243
    ds_read_b128 v[72:75], v243 offset:1024
    s_waitcnt lgkmcnt(1)
    s_nop 0
    v_add_f32 v68, v68, v180
    v_add_f32 v69, v69, v181
    v_add_f32 v70, v70, v182
    v_add_f32 v71, v71, v183
    s_waitcnt lgkmcnt(0)
    v_add_f32 v72, v72, v184
    v_add_f32 v73, v73, v185
    v_add_f32 v74, v74, v186
    v_add_f32 v75, v75, v187
    v_permlane32_swap_b32 v68, v72
    v_permlane32_swap_b32 v69, v73
    v_permlane32_swap_b32 v70, v74
    v_permlane32_swap_b32 v71, v75
    v_lshlrev_b32 v244, 16, v236
    v_and_b32 v245, 0xffff0000, v236
    v_add_f32 v244, v244, v68
    v_add_f32 v245, v245, v69
    v_cvt_pk_bf16_f32 v236, v244, v245
    v_lshlrev_b32 v244, 16, v237
    v_and_b32 v245, 0xffff0000, v237
    v_add_f32 v244, v244, v70
    v_add_f32 v245, v245, v71
    v_cvt_pk_bf16_f32 v237, v244, v245
    v_lshlrev_b32 v244, 16, v238
    v_and_b32 v245, 0xffff0000, v238
    v_add_f32 v244, v244, v72
    v_add_f32 v245, v245, v73
    v_cvt_pk_bf16_f32 v238, v244, v245
    v_lshlrev_b32 v244, 16, v239
    v_and_b32 v245, 0xffff0000, v239
    v_add_f32 v244, v244, v74
    v_add_f32 v245, v245, v75
    v_cvt_pk_bf16_f32 v239, v244, v245
    buffer_store_dwordx4 v[236:239], v18, s[16:19], s46 offen
parallel_sum__softmax_full_mha__swiglu_ffn__prompt_kernel_b_fin:
    s_endpgm
parallel_sum__softmax_full_mha__swiglu_ffn__prompt_kernel_b_slow:
    s_lshr_b32 s59, s37, 1
    s_cmp_eq_u32 s59, 0
    s_cbranch_scc1 parallel_sum__softmax_full_mha__swiglu_ffn__prompt_kernel_b_sl_a
    v_mov_b32 v44, v28
    v_mov_b32 v45, v29
    v_mov_b32 v46, v30
    v_mov_b32 v47, v31
    v_mov_b32 v48, v32
    v_mov_b32 v49, v33
    v_mov_b32 v50, v34
    v_mov_b32 v51, v35
    s_branch parallel_sum__softmax_full_mha__swiglu_ffn__prompt_kernel_b_sl_b
parallel_sum__softmax_full_mha__swiglu_ffn__prompt_kernel_b_sl_a:
    v_mov_b32 v44, v20
    v_mov_b32 v45, v21
    v_mov_b32 v46, v22
    v_mov_b32 v47, v23
    v_mov_b32 v48, v24
    v_mov_b32 v49, v25
    v_mov_b32 v50, v26
    v_mov_b32 v51, v27
parallel_sum__softmax_full_mha__swiglu_ffn__prompt_kernel_b_sl_b:
    v_mov_b32 v240, 0
    v_cndmask_b32 v50, v50, v240, s[54:55]
    v_mov_b32 v148, 0
    v_mov_b32 v149, 0
    v_mov_b32 v150, 0
    v_mov_b32 v151, 0
    v_mov_b32 v152, 0
    v_mov_b32 v153, 0
    v_mov_b32 v154, 0
    v_mov_b32 v155, 0
    v_mov_b32 v156, 0
    v_mov_b32 v157, 0
    v_mov_b32 v158, 0
    v_mov_b32 v159, 0
    v_mov_b32 v160, 0
    v_mov_b32 v161, 0
    v_mov_b32 v162, 0
    v_mov_b32 v163, 0
    v_mov_b32 v248, 0xff800000
    s_lshl_b32 s60, s31, 18
    s_add_u32 s60, s60, 2097152
    s_mov_b32 s49, 64
parallel_sum__softmax_full_mha__swiglu_ffn__prompt_kernel_b_sloop:
    buffer_load_dwordx4 v[36:39], v1, s[20:23], s60 offen sc1
    buffer_load_dwordx4 v[40:43], v1, s[20:23], s60 offen offset:1024 sc1
    buffer_load_dwordx4 v[52:55], v1, s[20:23], s60 offen offset:2048 sc1
    buffer_load_dwordx4 v[56:59], v1, s[20:23], s60 offen offset:3072 sc1
    s_waitcnt vmcnt(3)
    v_mfma_f32_32x32x16_bf16 v[100:115], v[36:39], v[44:47], 0
    s_waitcnt vmcnt(2)
    v_mfma_f32_32x32x16_bf16 v[100:115], v[40:43], v[48:51], v[100:115]
    s_nop 11
    v_max3_f32 v240, v100, v101, v102
    v_max3_f32 v240, v240, v103, v104
    v_max3_f32 v240, v240, v105, v106
    v_max3_f32 v240, v240, v107, v108
    v_max3_f32 v240, v240, v109, v110
    v_max3_f32 v240, v240, v111, v112
    v_max3_f32 v240, v240, v113, v114
    v_max_f32 v240, v240, v115
    v_mov_b32 v241, v240
    s_nop 1
    v_permlane32_swap_b32 v240, v241
    v_max3_f32 v240, v240, v241, v248
    v_sub_f32 v241, v248, v240
    v_exp_f32 v241, v241
    v_mov_b32 v248, v240
    v_sub_f32 v100, v100, v248
    v_sub_f32 v101, v101, v248
    v_sub_f32 v102, v102, v248
    v_sub_f32 v103, v103, v248
    v_sub_f32 v104, v104, v248
    v_sub_f32 v105, v105, v248
    v_sub_f32 v106, v106, v248
    v_sub_f32 v107, v107, v248
    v_sub_f32 v108, v108, v248
    v_sub_f32 v109, v109, v248
    v_sub_f32 v110, v110, v248
    v_sub_f32 v111, v111, v248
    v_sub_f32 v112, v112, v248
    v_sub_f32 v113, v113, v248
    v_sub_f32 v114, v114, v248
    v_sub_f32 v115, v115, v248
    v_exp_f32 v100, v100
    v_exp_f32 v101, v101
    v_exp_f32 v102, v102
    v_exp_f32 v103, v103
    v_exp_f32 v104, v104
    v_exp_f32 v105, v105
    v_exp_f32 v106, v106
    v_exp_f32 v107, v107
    v_exp_f32 v108, v108
    v_exp_f32 v109, v109
    v_exp_f32 v110, v110
    v_exp_f32 v111, v111
    v_exp_f32 v112, v112
    v_exp_f32 v113, v113
    v_exp_f32 v114, v114
    v_exp_f32 v115, v115
    v_mul_f32 v148, v148, v241
    v_mul_f32 v149, v149, v241
    v_mul_f32 v150, v150, v241
    v_mul_f32 v151, v151, v241
    v_mul_f32 v152, v152, v241
    v_mul_f32 v153, v153, v241
    v_mul_f32 v154, v154, v241
    v_mul_f32 v155, v155, v241
    v_mul_f32 v156, v156, v241
    v_mul_f32 v157, v157, v241
    v_mul_f32 v158, v158, v241
    v_mul_f32 v159, v159, v241
    v_mul_f32 v160, v160, v241
    v_mul_f32 v161, v161, v241
    v_mul_f32 v162, v162, v241
    v_mul_f32 v163, v163, v241
    v_cvt_pk_bf16_f32 v132, v100, v101
    v_cvt_pk_bf16_f32 v133, v102, v103
    v_cvt_pk_bf16_f32 v134, v104, v105
    v_cvt_pk_bf16_f32 v135, v106, v107
    v_cvt_pk_bf16_f32 v136, v108, v109
    v_cvt_pk_bf16_f32 v137, v110, v111
    v_cvt_pk_bf16_f32 v138, v112, v113
    v_cvt_pk_bf16_f32 v139, v114, v115
    s_waitcnt vmcnt(1)
    v_mfma_f32_32x32x16_bf16 v[148:163], v[52:55], v[132:135], v[148:163]
    s_waitcnt vmcnt(0)
    v_mfma_f32_32x32x16_bf16 v[148:163], v[56:59], v[136:139], v[148:163]
    s_add_u32 s60, s60, 4096
    s_sub_u32 s49, s49, 1
    s_cmp_lg_u32 s49, 0
    s_cbranch_scc1 parallel_sum__softmax_full_mha__swiglu_ffn__prompt_kernel_b_sloop
    s_nop 7
    v_mov_b32 v243, v160
    v_mov_b32 v244, v160
    s_nop 1
    v_permlane32_swap_b32 v243, v244
    s_and_b32 s60, s37, 1
    s_cmp_eq_u32 s60, 0
    s_cbranch_scc1 parallel_sum__softmax_full_mha__swiglu_ffn__prompt_kernel_b_sl_c
    v_mov_b32 v68, v156
    v_mov_b32 v69, v157
    v_mov_b32 v70, v158
    v_mov_b32 v71, v159
    v_mov_b32 v72, v160
    v_mov_b32 v73, v161
    v_mov_b32 v74, v162
    v_mov_b32 v75, v163
    s_branch parallel_sum__softmax_full_mha__swiglu_ffn__prompt_kernel_b_astore
parallel_sum__softmax_full_mha__swiglu_ffn__prompt_kernel_b_sl_c:
    v_mov_b32 v68, v148
    s_nop 0
    v_mov_b32 v69, v149
    v_mov_b32 v70, v150
    v_mov_b32 v71, v151
    v_mov_b32 v72, v152
    v_mov_b32 v73, v153
    v_mov_b32 v74, v154
    v_mov_b32 v75, v155
    s_branch parallel_sum__softmax_full_mha__swiglu_ffn__prompt_kernel_b_astore
parallel_sum__softmax_full_mha__swiglu_ffn__prompt_kernel_end:
    s_endpgm
.section .rodata,"a"
.p2align 6

.amdhsa_kernel parallel_sum__softmax_full_mha__swiglu_ffn__prompt_kernel
  .amdhsa_next_free_vgpr 256
  .amdhsa_next_free_sgpr 102
  .amdhsa_accum_offset 256
  .amdhsa_group_segment_fixed_size 0
  .amdhsa_kernarg_size 80
  .amdhsa_user_sgpr_count 2
  .amdhsa_user_sgpr_kernarg_segment_ptr 1
  .amdhsa_system_sgpr_workgroup_id_x 1
  .amdhsa_float_denorm_mode_32 3
.end_amdhsa_kernel
```
